```python
import torch

def _softmax(x, axis=-1):
    return torch.softmax(x, dim=axis)
def _gelu(x):
    return torch.nn.functional.gelu(x, approximate="tanh")
def _silu(x):
    return torch.nn.functional.silu(x)
def _sigmoid(x):
    return torch.sigmoid(x)
def _layernorm(x, axis=-1, eps=1e-5):
    m = x.mean(dim=axis, keepdim=True)
    v = x.var(dim=axis, keepdim=True, unbiased=False)
    return (x - m) / torch.sqrt(v + eps)
def _scatter_add(tgt, idx, src, axis=0):
    return tgt.clone().index_add_(axis, idx, src)
def _segment_sum(src, seg, n):
    out = torch.zeros((n,) + src.shape[1:], dtype=src.dtype)
    return out.index_add_(0, seg, src)
def _pad(x, pw):
    flat = tuple(v for pair in reversed(pw) for v in pair)
    return torch.nn.functional.pad(x, flat)

kernel_name = 'sequential_preLN__sliding_block_cached__geglu_ffn__decode'

def setup_inputs():

    _w = (lambda a: (lambda t: t.to(torch.bfloat16) if t.is_floating_point() else t)(torch.as_tensor(a)))
    def _A_setup():
        B, Sq, D = 4, 1, 576
        Hq, Hkv, Sk, Dh = 32, 16, 8192, 128
        assert Hq % Hkv == 0, (Hq, Hkv)
        return {
            "x": _w((lambda *s: torch.randn(*s, dtype=torch.bfloat16) * 0.05)(B, Sq, D)),
            "k_cache": _w((lambda *s: torch.randn(*s, dtype=torch.bfloat16) * 3.2)(B, Hkv, Sk, Dh)),
            "v_cache": _w((lambda *s: torch.randn(*s, dtype=torch.bfloat16) * 0.4)(B, Hkv, Sk, Dh)),
            "wq": _w((lambda *s: torch.randn(*s, dtype=torch.bfloat16) * 3.2)(D, Hq * Dh) * (D ** -0.5)),
            "wo": _w((lambda *s: torch.randn(*s, dtype=torch.bfloat16) * 0.4)(Hq * Dh, D) * ((Hq * Dh) ** -0.5)),
        }
    _A_in = _A_setup()

    def _B_setup():
        B, S, D, F = 4, 1, 576, 4608
        return {
            "x": _w((lambda *s: torch.randn(*s, dtype=torch.bfloat16) * 0.05)(B, S, D)),
            "w_gate": _w((lambda *s: torch.randn(*s, dtype=torch.bfloat16) * 0.05)(D, F)),
            "w_up": _w((lambda *s: torch.randn(*s, dtype=torch.bfloat16) * 0.05)(D, F)),
            "w_down": _w((lambda *s: torch.randn(*s, dtype=torch.bfloat16) * 0.05)(F, D)),
        }
    _B_in = _B_setup()

    return {
        "A_x": _A_in["x"],
        "A_k_cache": _A_in["k_cache"],
        "A_v_cache": _A_in["v_cache"],
        "A_wq": _A_in["wq"],
        "A_wo": _A_in["wo"],
        "B_x": _B_in["x"],
        "B_w_gate": _B_in["w_gate"],
        "B_w_up": _B_in["w_up"],
        "B_w_down": _B_in["w_down"],
    }

def reference(A_x, A_k_cache, A_v_cache, A_wq, A_wo, B_x, B_w_gate, B_w_up, B_w_down):
    def _A_ref(x, k_cache, v_cache, wq, wo):
        B, Sq, D = x.shape
        Hq, Dh = 32, 128
        Hkv, Sk = k_cache.shape[1], k_cache.shape[2]
        W = min(4096, max(256, Sk // 4))
        rep = Hq // Hkv
        q = (lambda x, *d: x.permute(*d))((x @ wq).reshape(B, Sq, Hq, Dh), 0, 2, 1, 3)
        k = (lambda x, n, axis: torch.repeat_interleave(x, n, dim=axis))(k_cache[:, :, Sk - W:, :], rep, axis=1)
        v = (lambda x, n, axis: torch.repeat_interleave(x, n, dim=axis))(v_cache[:, :, Sk - W:, :], rep, axis=1)
        scores = torch.einsum("bhqd,bhkd->bhqk", q, k) * (Dh ** -0.5)
        p = _softmax(scores, axis=-1)
        o = torch.einsum("bhqk,bhkd->bhqd", p, v)
        return (lambda x, *d: x.permute(*d))(o, 0, 2, 1, 3).reshape(B, Sq, Hq * Dh) @ wo

    def _B_ref(x, w_gate, w_up, w_down):
        return (_gelu(x @ w_gate) * (x @ w_up)) @ w_down

    x = A_x
    h = x + _A_ref(_layernorm(x, axis=-1), A_k_cache, A_v_cache, A_wq, A_wo)
    h2 = h + _B_ref(_layernorm(h, axis=-1), B_w_gate, B_w_up, B_w_down)
    return h2
```

```asm
; @launch grid=(256,1,1) block=(256,1,1) lds=163584
.amdgcn_target "amdgcn-amd-amdhsa--gfx950"
.text
.globl sequential_preLN__sliding_block_cached__geglu_ffn__decode_kernel
.p2align 8
.type sequential_preLN__sliding_block_cached__geglu_ffn__decode_kernel,@function
sequential_preLN__sliding_block_cached__geglu_ffn__decode_kernel:
    s_cmp_ge_u32 s2, 256
    s_cbranch_scc1 L_end
    s_load_dwordx16 s[44:59], s[0:1], 0
    s_load_dwordx8 s[60:67], s[0:1], 64
    v_lshrrev_b32 v1, 6, v0
    s_and_b32 s4, s2, 7
    s_lshr_b32 s5, s2, 3
    v_readfirstlane_b32 s3, v1
    s_cmp_eq_u32 s5, 31
    s_cbranch_scc0 L_nopfc
    s_getpc_b64 s[82:83]
L_pc:
    v_lshlrev_b32_e64 v97, 7, v0
    v_cmp_gt_u32 vcc, L_end-L_pc, v97
    s_and_saveexec_b64 s[70:71], vcc
    s_cbranch_execz L_pc2
    global_load_dword v206, v97, s[82:83]
L_pc2:
    s_mov_b64 exec, -1
L_nopfc:
    v_and_b32 v0, 63, v0
    s_lshr_b32 s76, s5, 4
    s_lshl_b32 s74, s4, 1
    s_add_u32 s76, s76, s74
    s_and_b32 s77, s5, 15
    s_movk_i32 s69, 0x7fff
    s_lshl_b32 s68, s2, 2
    s_add_u32 s68, s68, s3
    s_mul_i32 s68, s68, 0x9E3779B1
    s_lshr_b32 s68, s68, 27
    s_lshl_b32 s68, s68, 10
    v_bfe_u32 v92, v0, 2, 2
    v_lshrrev_b32 v93, 4, v0
    v_and_b32 v94, 3, v0
    v_lshlrev_b32 v1, 8, v92
    v_lshl_add_u32 v1, v93, 6, v1
    v_lshl_add_u32 v1, v94, 4, v1
    v_lshrrev_b32 v96, 3, v0
    v_and_b32 v98, 7, v0
    v_lshlrev_b32 v2, 4, v0
    s_and_b32 s82, s3, 1
    s_lshl_b32 s82, s82, 2
    v_and_b32 v95, 2, v96
    v_or_b32 v95, s82, v95
    v_xor_b32 v95, v95, v98
    v_lshlrev_b32 v95, 4, v95
    s_lshr_b32 s82, s77, 2
    s_lshl_b32 s82, s82, 4
    s_add_u32 s82, s82, s76
    s_lshl_b32 s82, s82, 21
    s_and_b32 s83, s77, 3
    s_lshl_b32 s83, s83, 2
    s_add_u32 s83, s83, s3
    s_lshl_b32 s83, s83, 15
    s_add_u32 s82, s82, s83
    s_add_u32 s82, s82, 1572864
    s_mov_b32 s10, 32768
    s_mov_b32 s11, 0x20000
    s_mov_b32 s18, 4718592
    s_mov_b32 s19, 0x20000
    s_mov_b32 s22, 1700864
    s_mov_b32 s23, 0x20000
    s_movk_i32 s26, 4608
    s_mov_b32 s27, 0x20000
    s_mov_b32 s78, 0xffff0000
    s_getreg_b32 s42, hwreg(HW_REG_XCC_ID, 0, 3)
    s_lshr_b32 s70, s5, 1
    s_lshl_b32 s70, s70, 3
    s_add_u32 s70, s70, s4
    s_mov_b32 s41, s82
    s_cmp_lt_u32 s5, 10
    s_cbranch_scc1 L_df
    s_cmp_lt_u32 s5, 27
    s_cbranch_scc0 L_dr
    s_lshl_b32 s83, s3, 10
    s_mov_b32 m0, s83
    s_cmp_lt_u32 s5, 18
    s_cbranch_scc1 L_dq
    s_mov_b32 s6, 1
    s_sub_u32 s7, s5, 18
    s_mov_b32 s71, 36864
    s_mul_i32 s73, s4, 589824
    s_lshl_b32 s82, s7, 7
    s_add_u32 s73, s73, s82
    s_mul_i32 s82, s3, 9216
    s_add_u32 s73, s73, s82
    v_mul_u32_u24 v3, 1152, v96
    v_add_u32 v3, v3, v95
    s_waitcnt lgkmcnt(0)
    s_load_dword s54, s[66:67], 65536
    s_mov_b64 s[16:17], s[52:53]
    s_mov_b64 s[20:21], s[66:67]
    s_mov_b64 s[24:25], s[44:45]
    s_add_u32 s8, s46, s41
    s_addc_u32 s9, s47, 0
    s_branch L_dma
L_dr:
    s_mov_b32 s6, 3
    s_sub_u32 s7, s5, 27
    s_lshl_b32 s73, s7, 2
    s_add_u32 s73, s73, s3
    s_lshl_b32 s73, s73, 3
    s_add_u32 s73, s73, 416
    s_lshl_b32 s73, s73, 13
    s_lshl_b32 s74, s4, 10
    s_add_u32 s73, s73, s74
    v_lshlrev_b32 v97, 7, v98
    v_lshl_add_u32 v97, v96, 13, v97
    s_lshl_b32 s7, s7, 3
    s_add_u32 s7, s7, s4
    s_lshl_b32 s75, s7, 2
    s_add_u32 s75, s75, s3
    s_lshl_b32 s75, s75, 10
    s_add_u32 s75, s75, 450560
    s_mov_b32 s22, 619520
    v_mov_b32 v184, -1
    v_mov_b32 v185, -1
    v_mov_b32 v186, -1
    v_mov_b32 v187, -1
    s_waitcnt lgkmcnt(0)
    s_load_dword s54, s[66:67], 65536
    s_mov_b64 s[16:17], s[50:51]
    s_mov_b64 s[20:21], s[66:67]
    s_mov_b64 s[24:25], s[44:45]
    buffer_store_dwordx4 v[184:187], v2, s[20:23], s75 offen sc1
    s_cmp_lt_u32 s7, 2
    s_cbranch_scc0 L_tq
    s_add_u32 s75, s75, 163840
    buffer_store_dwordx4 v[184:187], v2, s[20:23], s75 offen sc1
L_tq:
    buffer_load_dword v207, v97, s[16:19], s73 offen
    s_mov_b32 s22, 1700864
    s_add_u32 s8, s46, s41
    s_addc_u32 s9, s47, 0
    s_waitcnt lgkmcnt(0)
    s_add_u32 s54, s54, 16
    s_add_u32 s43, s54, s42
    s_or_b32 s0, s54, 1
    s_cmp_eq_u32 s3, 1
    s_cbranch_scc0 L_np_1
    s_lshl_b32 s40, s4, 5
    s_add_u32 s40, s40, s5
    s_lshl_b32 s40, s40, 7
    s_add_u32 s40, s40, 66560
    v_mov_b32 v97, s43
    v_lshlrev_b32 v98, 2, v0
    s_mov_b32 exec_hi, 0
    buffer_store_dword v97, v98, s[20:23], s40 offen
    s_mov_b32 exec_hi, -1
L_np_1:
    s_mul_i32 s82, s7, 128
    s_add_u32 s82, s82, 99328
    s_cmp_eq_u32 s3, 0
    s_waitcnt vmcnt(1)
    s_barrier
    s_cbranch_scc0 L_kld
    v_mov_b32 v97, s54
    v_lshlrev_b32_e64 v98, 2, v0
    s_mov_b32 exec_hi, 0
    buffer_store_dword v97, v98, s[20:23], s82 offen sc1
    s_mov_b32 exec_hi, -1
    s_branch L_kld
L_df:
    s_mov_b32 s6, 2
    s_lshl_b32 s73, s5, 2
    s_add_u32 s73, s73, s3
    s_mul_i32 s73, s73, 12
    s_add_u32 s73, s73, 0xffffffc0
    s_lshl_b32 s73, s73, 13
    s_lshl_b32 s74, s4, 10
    s_add_u32 s73, s73, s74
    v_lshlrev_b32 v97, 7, v98
    v_lshl_add_u32 v97, v96, 13, v97
    s_add_u32 s74, s73, 65536
    s_cmp_lt_u32 s70, 9
    s_waitcnt lgkmcnt(0)
    s_load_dword s54, s[66:67], 65536
    s_mov_b64 s[16:17], s[50:51]
    s_mov_b64 s[20:21], s[66:67]
    s_mov_b64 s[24:25], s[44:45]
    s_cbranch_scc1 L_notq
    buffer_load_dword v207, v97, s[16:19], s73 offen
    s_mov_b32 exec_lo, 0xffffffff
    s_mov_b32 exec_hi, 0x0
    buffer_load_dword v208, v97, s[16:19], s74 offen
    s_mov_b64 exec, -1
L_notq:
    s_add_u32 s8, s46, s41
    s_addc_u32 s9, s47, 0
    s_branch L_kx
L_dq:
    s_mov_b32 s6, 0
    s_lshl_b32 s7, s4, 3
    s_add_u32 s7, s7, s5
    s_sub_u32 s7, s7, 10
    s_mov_b32 s71, 262144
    s_lshl_b32 s73, s7, 7
    s_lshl_b32 s82, s3, 16
    s_add_u32 s73, s73, s82
    v_lshl_add_u32 v3, v96, 13, v95
    s_mul_i32 s82, s3, 1152
    v_mov_b32 v188, 0
    v_mov_b32 v189, 0
    v_mov_b32 v190, 0
    v_mov_b32 v191, 0
    v_mov_b32 v192, 0
    v_mov_b32 v193, 0
    v_mov_b32 v194, 0
    v_mov_b32 v195, 0
    s_waitcnt lgkmcnt(0)
    s_load_dword s54, s[66:67], 65536
    s_mov_b64 s[16:17], s[50:51]
    s_mov_b64 s[20:21], s[66:67]
    s_mov_b64 s[24:25], s[44:45]
    s_mov_b32 exec_hi, 15
    buffer_load_dwordx4 v[188:191], v2, s[24:27], s82 offen
    buffer_load_dwordx4 v[192:195], v2, s[24:27], s82 offen offset:576
    s_mov_b32 exec_hi, -1
    s_add_u32 s8, s46, s41
    s_addc_u32 s9, s47, 0
L_dma:
    buffer_load_dwordx4 v3, s[16:19], s73 offen nt lds
    s_addk_i32 m0, 0x1000
    s_add_u32 s73, s73, s71
    buffer_load_dwordx4 v3, s[16:19], s73 offen nt lds
    s_addk_i32 m0, 0x1000
    s_add_u32 s73, s73, s71
    buffer_load_dwordx4 v3, s[16:19], s73 offen nt lds
    s_addk_i32 m0, 0x1000
    s_add_u32 s73, s73, s71
    buffer_load_dwordx4 v3, s[16:19], s73 offen nt lds
    s_addk_i32 m0, 0x1000
    s_add_u32 s73, s73, s71
    buffer_load_dwordx4 v3, s[16:19], s73 offen nt lds
    s_addk_i32 m0, 0x1000
    s_add_u32 s73, s73, s71
    s_waitcnt lgkmcnt(0)
    s_add_u32 s54, s54, 16
    s_add_u32 s43, s54, s42
    s_or_b32 s0, s54, 1
    s_cmp_eq_u32 s3, 1
    s_cbranch_scc0 L_np_2
    s_lshl_b32 s40, s4, 5
    s_add_u32 s40, s40, s5
    s_lshl_b32 s40, s40, 7
    s_add_u32 s40, s40, 66560
    v_mov_b32 v97, s43
    v_lshlrev_b32 v98, 2, v0
    s_mov_b32 exec_hi, 0
    buffer_store_dword v97, v98, s[20:23], s40 offen
    s_mov_b32 exec_hi, -1
L_np_2:
    s_cmp_eq_u32 s6, 0
    s_cbranch_scc0 L_noln
    s_waitcnt vmcnt(5)
    v_lshlrev_b32 v172, 16, v188
    v_and_b32 v173, s78, v188
    v_lshlrev_b32 v174, 16, v189
    v_and_b32 v175, s78, v189
    v_lshlrev_b32 v176, 16, v190
    v_and_b32 v177, s78, v190
    v_lshlrev_b32 v178, 16, v191
    v_and_b32 v179, s78, v191
    v_lshlrev_b32 v180, 16, v192
    v_and_b32 v181, s78, v192
    v_lshlrev_b32 v182, 16, v193
    v_and_b32 v183, s78, v193
    v_lshlrev_b32 v184, 16, v194
    v_and_b32 v185, s78, v194
    v_lshlrev_b32 v186, 16, v195
    v_and_b32 v187, s78, v195
    v_add_f32 v196, v172, v173
    v_add_f32 v196, v196, v174
    v_add_f32 v196, v196, v175
    v_add_f32 v196, v196, v176
    v_add_f32 v196, v196, v177
    v_add_f32 v196, v196, v178
    v_add_f32 v196, v196, v179
    v_add_f32 v196, v196, v180
    v_add_f32 v196, v196, v181
    v_add_f32 v196, v196, v182
    v_add_f32 v196, v196, v183
    v_add_f32 v196, v196, v184
    v_add_f32 v196, v196, v185
    v_add_f32 v196, v196, v186
    v_add_f32_e64 v196, v196, v187
    s_nop 1
    v_add_f32_dpp v196, v196, v196 quad_perm:[1,0,3,2] row_mask:0xf bank_mask:0xf
    s_nop 1
    v_add_f32_dpp v196, v196, v196 quad_perm:[2,3,0,1] row_mask:0xf bank_mask:0xf
    s_nop 1
    v_add_f32_dpp v196, v196, v196 row_half_mirror row_mask:0xf bank_mask:0xf
    s_nop 1
    v_add_f32_dpp v196, v196, v196 row_mirror row_mask:0xf bank_mask:0xf
    v_mov_b32 v197, v196
    s_nop 1
    v_permlane16_swap_b32 v196, v197
    v_add_f32 v196, v196, v197
    v_mov_b32 v197, v196
    s_nop 1
    v_permlane32_swap_b32 v196, v197
    v_add_f32 v196, v196, v197
    v_mul_f32 v196, 0x3ae38e39, v196
    v_sub_f32 v198, v172, v196
    v_mul_f32 v197, v198, v198
    v_sub_f32 v198, v173, v196
    v_fmac_f32 v197, v198, v198
    v_sub_f32 v198, v174, v196
    v_fmac_f32 v197, v198, v198
    v_sub_f32 v198, v175, v196
    v_fmac_f32 v197, v198, v198
    v_sub_f32 v198, v176, v196
    v_fmac_f32 v197, v198, v198
    v_sub_f32 v198, v177, v196
    v_fmac_f32 v197, v198, v198
    v_sub_f32 v198, v178, v196
    v_fmac_f32 v197, v198, v198
    v_sub_f32 v198, v179, v196
    v_fmac_f32 v197, v198, v198
    v_sub_f32 v198, v180, v196
    v_fmac_f32 v197, v198, v198
    v_sub_f32 v198, v181, v196
    v_fmac_f32 v197, v198, v198
    v_sub_f32 v198, v182, v196
    v_fmac_f32 v197, v198, v198
    v_sub_f32 v198, v183, v196
    v_fmac_f32 v197, v198, v198
    v_sub_f32 v198, v184, v196
    v_fmac_f32 v197, v198, v198
    v_sub_f32 v198, v185, v196
    v_fmac_f32 v197, v198, v198
    v_sub_f32 v198, v186, v196
    v_fmac_f32 v197, v198, v198
    v_sub_f32 v198, v187, v196
    v_fmac_f32 v197, v198, v198
    v_cmp_gt_u32 vcc, 36, v0
    s_nop 1
    v_cndmask_b32 v197, 0, v197, vcc
    s_nop 1
    v_add_f32_dpp v197, v197, v197 quad_perm:[1,0,3,2] row_mask:0xf bank_mask:0xf
    s_nop 1
    v_add_f32_dpp v197, v197, v197 quad_perm:[2,3,0,1] row_mask:0xf bank_mask:0xf
    s_nop 1
    v_add_f32_dpp v197, v197, v197 row_half_mirror row_mask:0xf bank_mask:0xf
    s_nop 1
    v_add_f32_dpp v197, v197, v197 row_mirror row_mask:0xf bank_mask:0xf
    v_mov_b32 v198, v197
    s_nop 1
    v_permlane16_swap_b32 v197, v198
    v_add_f32 v197, v197, v198
    v_mov_b32 v198, v197
    s_nop 1
    v_permlane32_swap_b32 v197, v198
    v_add_f32 v197, v197, v198
    v_mul_f32 v197, 0x3ae38e39, v197
    v_cvt_pk_bf16_f32 v196, v196, v196
    v_and_b32 v196, s78, v196
    v_cvt_pk_bf16_f32 v197, v197, v197
    v_and_b32 v197, s78, v197
    v_add_f32 v197, 0x3727c5ac, v197
    v_cvt_pk_bf16_f32 v197, v197, v197
    v_and_b32 v197, s78, v197
    v_sqrt_f32 v197, v197
    s_nop 0
    v_cvt_pk_bf16_f32 v197, v197, v197
    v_and_b32 v197, s78, v197
    v_rcp_f32 v197, v197
    v_sub_f32 v172, v172, v196
    v_sub_f32 v173, v173, v196
    v_cvt_pk_bf16_f32 v198, v172, v173
    v_lshlrev_b32 v172, 16, v198
    v_and_b32 v173, s78, v198
    v_mul_f32 v172, v172, v197
    v_mul_f32_e64 v173, v173, v197
    v_cvt_pk_bf16_f32 v188, v172, v173
    v_sub_f32 v174, v174, v196
    v_sub_f32 v175, v175, v196
    v_cvt_pk_bf16_f32 v198, v174, v175
    v_lshlrev_b32 v174, 16, v198
    v_and_b32 v175, s78, v198
    v_mul_f32 v174, v174, v197
    v_mul_f32 v175, v175, v197
    v_cvt_pk_bf16_f32 v189, v174, v175
    v_sub_f32 v176, v176, v196
    v_sub_f32 v177, v177, v196
    v_cvt_pk_bf16_f32 v198, v176, v177
    v_lshlrev_b32 v176, 16, v198
    v_and_b32 v177, s78, v198
    v_mul_f32 v176, v176, v197
    v_mul_f32 v177, v177, v197
    v_cvt_pk_bf16_f32 v190, v176, v177
    v_sub_f32 v178, v178, v196
    v_sub_f32 v179, v179, v196
    v_cvt_pk_bf16_f32 v198, v178, v179
    v_lshlrev_b32 v178, 16, v198
    v_and_b32 v179, s78, v198
    v_mul_f32 v178, v178, v197
    v_mul_f32 v179, v179, v197
    v_cvt_pk_bf16_f32 v191, v178, v179
    v_sub_f32 v180, v180, v196
    v_sub_f32 v181, v181, v196
    v_cvt_pk_bf16_f32 v198, v180, v181
    v_lshlrev_b32 v180, 16, v198
    v_and_b32 v181, s78, v198
    v_mul_f32 v180, v180, v197
    v_mul_f32 v181, v181, v197
    v_cvt_pk_bf16_f32 v192, v180, v181
    v_sub_f32 v182, v182, v196
    v_sub_f32 v183, v183, v196
    v_cvt_pk_bf16_f32 v198, v182, v183
    v_lshlrev_b32 v182, 16, v198
    v_and_b32 v183, s78, v198
    v_mul_f32 v182, v182, v197
    v_mul_f32 v183, v183, v197
    v_cvt_pk_bf16_f32 v193, v182, v183
    v_sub_f32 v184, v184, v196
    v_sub_f32 v185, v185, v196
    v_cvt_pk_bf16_f32 v198, v184, v185
    v_lshlrev_b32 v184, 16, v198
    v_and_b32 v185, s78, v198
    v_mul_f32 v184, v184, v197
    v_mul_f32 v185, v185, v197
    v_cvt_pk_bf16_f32 v194, v184, v185
    v_sub_f32 v186, v186, v196
    v_sub_f32 v187, v187, v196
    v_cvt_pk_bf16_f32 v198, v186, v187
    v_lshlrev_b32 v186, 16, v198
    v_and_b32 v187, s78, v198
    v_mul_f32 v186, v186, v197
    v_mul_f32 v187, v187, v197
    v_cvt_pk_bf16_f32 v195, v186, v187
    v_lshrrev_b32 v198, 2, v0
    v_mul_u32_u24 v198, 272, v198
    v_lshl_add_u32 v198, v94, 6, v198
    s_lshl_b32 s82, s3, 4
    s_add_u32 s82, s82, 147456
    v_add_u32_e64 v198, s82, v198
    s_mov_b64 exec, vcc
    ds_write_b128 v198, v[188:191]
    ds_write_b128 v198, v[192:195] offset:2448
    s_mov_b64 exec, -1
L_noln:
    buffer_load_dwordx4 v3, s[16:19], s73 offen nt lds
    s_addk_i32 m0, 0x1000
    s_add_u32 s73, s73, s71
    buffer_load_dwordx4 v3, s[16:19], s73 offen nt lds
    s_addk_i32 m0, 0x1000
    s_add_u32 s73, s73, s71
    buffer_load_dwordx4 v3, s[16:19], s73 offen nt lds
    s_addk_i32 m0, 0x1000
    s_add_u32 s73, s73, s71
    s_waitcnt vmcnt(7)
    buffer_load_dwordx4 v3, s[16:19], s73 offen nt lds
    s_addk_i32 m0, 0x1000
    s_add_u32 s73, s73, s71
    s_waitcnt vmcnt(7)
    buffer_load_dwordx4 v3, s[16:19], s73 offen nt lds
    s_addk_i32 m0, 0x1000
    s_add_u32 s73, s73, s71
    s_waitcnt vmcnt(7)
    buffer_load_dwordx4 v3, s[16:19], s73 offen nt lds
    s_addk_i32 m0, 0x1000
    s_add_u32 s73, s73, s71
    s_waitcnt vmcnt(7)
    buffer_load_dwordx4 v3, s[16:19], s73 offen nt lds
    s_addk_i32 m0, 0x1000
    s_add_u32 s73, s73, s71
    s_waitcnt vmcnt(7)
    buffer_load_dwordx4 v3, s[16:19], s73 offen nt lds
    s_addk_i32 m0, 0x1000
    s_add_u32 s73, s73, s71
    s_waitcnt vmcnt(7)
    buffer_load_dwordx4 v3, s[16:19], s73 offen nt lds
    s_addk_i32 m0, 0x1000
    s_add_u32 s73, s73, s71
    s_waitcnt vmcnt(7)
    buffer_load_dwordx4 v3, s[16:19], s73 offen nt lds
    s_addk_i32 m0, 0x1000
    s_add_u32 s73, s73, s71
    s_waitcnt vmcnt(7)
    buffer_load_dwordx4 v3, s[16:19], s73 offen nt lds
    s_addk_i32 m0, 0x1000
    s_add_u32 s73, s73, s71
    s_cmp_eq_u32 s6, 1
    s_cbranch_scc1 L_kld
    s_waitcnt vmcnt(7)
    buffer_load_dwordx4 v3, s[16:19], s73 offen nt lds
    s_addk_i32 m0, 0x1000
    s_add_u32 s73, s73, s71
    s_waitcnt vmcnt(7)
    buffer_load_dwordx4 v3, s[16:19], s73 offen nt lds
    s_cmp_eq_u32 s3, 0
    s_cbranch_scc0 L_kx
    s_lshr_b32 s82, s7, 2
    s_lshl_b32 s82, s82, 11
    s_add_u32 s82, s82, 66560
    v_lshlrev_b32 v97, 7, v0
    v_mov_b32 v206, s43
    s_mov_b64 exec, 0xffff
    buffer_load_dword v206, v97, s[20:23], s82 offen sc1
    s_mov_b64 exec, -1
L_kx:
    s_mul_i32 s82, s3, 1152
    s_add_u32 m0, s82, 158464
    s_mov_b32 exec_hi, 15
    buffer_load_dwordx4 v2, s[24:27], s82 offen lds
    buffer_load_dwordx4 v2, s[24:27], s82 offen offset:576 lds
    s_mov_b32 exec_hi, -1
L_kld:
    s_waitcnt vmcnt(5)
    buffer_load_dwordx4 a[0:3], v1, s[8:11], s68 offen nt
    s_addk_i32 s68, 1024
    s_and_b32 s68, s68, s69
    s_mov_b64 s[28:29], s[56:57]
    s_mov_b32 s30, 5308416
    s_mov_b32 s31, 0x20000
    s_mov_b64 s[32:33], s[58:59]
    s_mov_b32 s34, 5308416
    s_mov_b32 s35, 0x20000
    s_mov_b64 s[36:37], s[62:63]
    s_mov_b32 s38, 4608
    s_mov_b32 s39, 0x20000
    s_mov_b64 s[24:25], s[60:61]
    s_mov_b32 s26, 5308416
    s_mov_b32 s27, 0x20000
    s_mov_b32 s79, 0x3db504f3
    s_mov_b32 s80, 0x3fb8aa3b
    s_waitcnt vmcnt(5)
    buffer_load_dwordx4 a[4:7], v1, s[8:11], s68 offen nt
    s_addk_i32 s68, 1024
    s_and_b32 s68, s68, s69
    v_lshrrev_b32 v97, 1, v92
    v_and_b32 v98, 1, v93
    v_lshl_or_b32 v97, v98, 1, v97
    v_xor_b32 v97, s3, v97
    v_lshl_add_u32 v4, v93, 3, v92
    v_lshlrev_b32_e64 v4, 7, v4
    v_lshl_add_u32 v4, v97, 5, v4
    v_lshl_add_u32 v4, v94, 3, v4
    v_add_u32 v5, 36864, v4
    s_waitcnt vmcnt(5)
    buffer_load_dwordx4 a[8:11], v1, s[8:11], s68 offen nt
    s_addk_i32 s68, 1024
    s_and_b32 s68, s68, s69
    s_add_u32 s12, s48, s41
    s_addc_u32 s13, s49, 0
    s_mov_b32 s14, 32768
    s_mov_b32 s15, 0x20000
    s_and_b32 s51, s5, 1
    s_lshl_b32 s52, s70, 2
    s_add_u32 s52, s52, s3
    s_lshl_b32 s52, s52, 10
    s_add_u32 s52, s52, 122880
    s_lshr_b32 s74, s3, 1
    s_cmp_eq_u32 s74, s51
    s_cselect_b32 s53, 1, 0
    s_waitcnt vmcnt(5)
    buffer_load_dwordx4 a[12:15], v1, s[8:11], s68 offen nt
    s_addk_i32 s68, 1024
    s_and_b32 s68, s68, s69
    s_cmp_eq_u32 s6, 2
    s_cbranch_scc0 L_nf
    s_waitcnt lgkmcnt(0)
    s_add_u32 s54, s54, 16
    s_add_u32 s43, s54, s42
    s_or_b32 s0, s54, 1
    s_cmp_eq_u32 s3, 1
    s_cbranch_scc0 L_np_3
    s_lshl_b32 s40, s4, 5
    s_add_u32 s40, s40, s5
    s_lshl_b32 s40, s40, 7
    s_add_u32 s40, s40, 66560
    v_mov_b32 v97, s43
    v_lshlrev_b32_e64 v98, 2, v0
    s_mov_b32 exec_hi, 0
    buffer_store_dword v97, v98, s[20:23], s40 offen
    s_mov_b32 exec_hi, -1
L_np_3:
L_nf:
    s_waitcnt vmcnt(5)
    buffer_load_dwordx4 a[16:19], v1, s[8:11], s68 offen nt
    s_addk_i32 s68, 1024
    s_and_b32 s68, s68, s69
    s_waitcnt vmcnt(5)
    buffer_load_dwordx4 a[20:23], v1, s[8:11], s68 offen nt
    s_addk_i32 s68, 1024
    s_and_b32 s68, s68, s69
    s_waitcnt vmcnt(5)
    buffer_load_dwordx4 a[24:27], v1, s[8:11], s68 offen nt
    s_addk_i32 s68, 1024
    s_and_b32 s68, s68, s69
    s_waitcnt vmcnt(7) lgkmcnt(0)
    s_barrier
    buffer_load_dwordx4 a[28:31], v1, s[8:11], s68 offen nt
    s_addk_i32 s68, 1024
    s_and_b32 s68, s68, s69
    s_cmp_lt_u32 s6, 2
    s_cbranch_scc0 L_ne_4
    ds_read_b64_tr_b16 v[100:101], v4 offset:0
    ds_read_b64_tr_b16 v[102:103], v4 offset:512
    ds_read_b64_tr_b16 v[104:105], v4 offset:4096
    ds_read_b64_tr_b16 v[106:107], v4 offset:4608
    ds_read_b64_tr_b16 v[108:109], v4 offset:8192
    ds_read_b64_tr_b16 v[110:111], v4 offset:8704
    ds_read_b64_tr_b16 v[112:113], v4 offset:12288
    ds_read_b64_tr_b16 v[114:115], v4 offset:12800
    ds_read_b64_tr_b16 v[116:117], v4 offset:16384
    ds_read_b64_tr_b16 v[118:119], v4 offset:16896
    ds_read_b64_tr_b16 v[120:121], v4 offset:20480
    ds_read_b64_tr_b16 v[122:123], v4 offset:20992
L_ne_4:
    buffer_load_dwordx4 a[32:35], v1, s[8:11], s68 offen nt
    s_addk_i32 s68, 1024
    s_and_b32 s68, s68, s69
    s_cmp_lt_u32 s6, 2
    s_cbranch_scc0 L_ne_5
    ds_read_b64_tr_b16 v[124:125], v4 offset:24576
    ds_read_b64_tr_b16 v[126:127], v4 offset:25088
    ds_read_b64_tr_b16 v[128:129], v4 offset:28672
    ds_read_b64_tr_b16 v[130:131], v4 offset:29184
    ds_read_b64_tr_b16 v[132:133], v4 offset:32768
    ds_read_b64_tr_b16 v[134:135], v4 offset:33280
    ds_read_b64_tr_b16 v[136:137], v5 offset:0
    ds_read_b64_tr_b16 v[138:139], v5 offset:512
    ds_read_b64_tr_b16 v[140:141], v5 offset:4096
    ds_read_b64_tr_b16 v[142:143], v5 offset:4608
    ds_read_b64_tr_b16 v[144:145], v5 offset:8192
    ds_read_b64_tr_b16 v[146:147], v5 offset:8704
L_ne_5:
    buffer_load_dwordx4 a[36:39], v1, s[8:11], s68 offen nt
    s_addk_i32 s68, 1024
    s_and_b32 s68, s68, s69
    s_cmp_lt_u32 s6, 2
    s_cbranch_scc0 L_ne_6
    ds_read_b64_tr_b16 v[148:149], v5 offset:12288
    ds_read_b64_tr_b16 v[150:151], v5 offset:12800
    ds_read_b64_tr_b16 v[152:153], v5 offset:16384
    ds_read_b64_tr_b16 v[154:155], v5 offset:16896
    ds_read_b64_tr_b16 v[156:157], v5 offset:20480
    ds_read_b64_tr_b16 v[158:159], v5 offset:20992
    ds_read_b64_tr_b16 v[160:161], v5 offset:24576
    ds_read_b64_tr_b16 v[162:163], v5 offset:25088
    ds_read_b64_tr_b16 v[164:165], v5 offset:28672
    ds_read_b64_tr_b16 v[166:167], v5 offset:29184
    ds_read_b64_tr_b16 v[168:169], v5 offset:32768
    ds_read_b64_tr_b16 v[170:171], v5 offset:33280
L_ne_6:
    s_cmp_eq_u32 s6, 0
    s_cbranch_scc0 L_k1
    v_lshl_add_u32 v198, v93, 2, v94
    v_lshlrev_b32_e64 v198, 4, v198
    v_add_u32 v198, 147456, v198
    ds_read_b128 v[20:23], v198 offset:0
    ds_read_b128 v[24:27], v198 offset:272
    ds_read_b128 v[28:31], v198 offset:544
    ds_read_b128 v[32:35], v198 offset:816
    ds_read_b128 v[36:39], v198 offset:1088
    ds_read_b128 v[40:43], v198 offset:1360
    ds_read_b128 v[44:47], v198 offset:1632
    ds_read_b128 v[48:51], v198 offset:1904
    ds_read_b128 v[52:55], v198 offset:2176
    ds_read_b128 v[56:59], v198 offset:2448
    ds_read_b128 v[60:63], v198 offset:2720
    ds_read_b128 v[64:67], v198 offset:2992
    ds_read_b128 v[68:71], v198 offset:3264
    ds_read_b128 v[72:75], v198 offset:3536
    ds_read_b128 v[76:79], v198 offset:3808
    ds_read_b128 v[80:83], v198 offset:4080
    ds_read_b128 v[84:87], v198 offset:4352
    ds_read_b128 v[88:91], v198 offset:4624
    buffer_load_dwordx4 a[40:43], v1, s[8:11], s68 offen nt
    s_addk_i32 s68, 1024
    s_and_b32 s68, s68, s69
    s_waitcnt lgkmcnt(0)
    v_mfma_f32_16x16x32_bf16 v[16:19], v[100:103], v[20:23], 0
    v_mfma_f32_16x16x32_bf16 v[16:19], v[104:107], v[24:27], v[16:19]
    v_mfma_f32_16x16x32_bf16 v[16:19], v[108:111], v[28:31], v[16:19]
    v_mfma_f32_16x16x32_bf16 v[16:19], v[112:115], v[32:35], v[16:19]
    v_mfma_f32_16x16x32_bf16 v[16:19], v[116:119], v[36:39], v[16:19]
    v_mfma_f32_16x16x32_bf16 v[16:19], v[120:123], v[40:43], v[16:19]
    v_mfma_f32_16x16x32_bf16 v[16:19], v[124:127], v[44:47], v[16:19]
    v_mfma_f32_16x16x32_bf16 v[16:19], v[128:131], v[48:51], v[16:19]
    v_mfma_f32_16x16x32_bf16 v[16:19], v[132:135], v[52:55], v[16:19]
    buffer_load_dwordx4 a[44:47], v1, s[8:11], s68 offen nt
    s_addk_i32 s68, 1024
    s_and_b32 s68, s68, s69
    v_mfma_f32_16x16x32_bf16 v[16:19], v[136:139], v[56:59], v[16:19]
    v_mfma_f32_16x16x32_bf16 v[16:19], v[140:143], v[60:63], v[16:19]
    v_mfma_f32_16x16x32_bf16 v[16:19], v[144:147], v[64:67], v[16:19]
    v_mfma_f32_16x16x32_bf16 v[16:19], v[148:151], v[68:71], v[16:19]
    v_mfma_f32_16x16x32_bf16 v[16:19], v[152:155], v[72:75], v[16:19]
    v_mfma_f32_16x16x32_bf16 v[16:19], v[156:159], v[76:79], v[16:19]
    v_mfma_f32_16x16x32_bf16 v[16:19], v[160:163], v[80:83], v[16:19]
    v_mfma_f32_16x16x32_bf16 v[16:19], v[164:167], v[84:87], v[16:19]
    v_mfma_f32_16x16x32_bf16 v[16:19], v[168:171], v[88:91], v[16:19]
    buffer_load_dwordx4 a[48:51], v1, s[8:11], s68 offen nt
    s_addk_i32 s68, 1024
    s_and_b32 s68, s68, s69
    v_lshlrev_b32 v198, 8, v94
    v_bfe_u32 v97, v0, 4, 1
    v_lshl_add_u32 v198, v97, 6, v198
    v_bfe_u32 v97, v0, 5, 1
    v_lshl_add_u32 v198, v97, 4, v198
    s_lshr_b32 s83, s3, 1
    s_lshl_b32 s83, s83, 7
    s_and_b32 s82, s3, 1
    s_lshl_b32 s82, s82, 5
    s_add_u32 s83, s83, s82
    s_add_u32 s83, s83, 152576
    v_add_u32 v198, s83, v198
    v_add_u32 v199, 152576, v2
    v_and_b32 v97, 15, v0
    v_lshlrev_b32 v97, 4, v97
    v_lshl_add_u32 v97, v93, 14, v97
    s_lshl_b32 s82, s7, 8
    v_cvt_pk_bf16_f32 v16, v16, v17
    v_cvt_pk_bf16_f32 v18, v18, v19
    v_mov_b32 v17, s54
    v_mov_b32 v19, s54
    s_mov_b32 exec_lo, 0x000f000f
    s_mov_b32 exec_hi, 0x000f000f
    ds_write_b128 v198, v[16:19]
    s_mov_b64 exec, -1
    s_cmp_eq_u32 s3, 0
    s_waitcnt lgkmcnt(0)
    s_barrier
    s_cbranch_scc0 L_k2
    ds_read_b128 v[16:19], v199
    v_cmp_ne_u32 vcc, s43, v206
    s_cmp_eq_u64 vcc, 0
    s_cselect_b32 s55, 1, 0
    s_waitcnt lgkmcnt(0)
    s_cmp_eq_u32 s55, 1
    s_cbranch_scc0 L_far_7
    buffer_store_dwordx4 v[16:19], v97, s[20:23], s82 offen
    s_branch L_st_8
L_far_7:
    buffer_store_dwordx4 v[16:19], v97, s[20:23], s82 offen sc1
L_st_8:
    s_branch L_k2
L_k1:
    s_waitcnt vmcnt(5)
    buffer_load_dwordx4 a[40:43], v1, s[8:11], s68 offen nt
    s_addk_i32 s68, 1024
    s_and_b32 s68, s68, s69
    s_waitcnt vmcnt(5)
    buffer_load_dwordx4 a[44:47], v1, s[8:11], s68 offen nt
    s_addk_i32 s68, 1024
    s_and_b32 s68, s68, s69
    s_waitcnt vmcnt(5)
    buffer_load_dwordx4 a[48:51], v1, s[8:11], s68 offen nt
    s_addk_i32 s68, 1024
    s_and_b32 s68, s68, s69
L_k2:
    s_cmp_lt_u32 s70, 9
    s_cselect_b32 s72, 40, 0
    s_cmp_eq_u32 s6, 3
    s_cselect_b32 s72, 8, s72
    s_cmp_eq_u32 s6, 0
    s_cselect_b32 s72, 17, s72
    s_cmp_eq_u32 s6, 1
    s_cselect_b32 s72, 17, s72
    v_and_b32 v97, 7, v0
    v_mul_u32_u24 v205, 1024, v96
    v_lshl_add_u32 v205, v97, 4, v205
    s_cmp_gt_u32 s72, 0
    s_cbranch_scc1 L_t_9
    s_waitcnt vmcnt(5)
L_t_9:
    buffer_load_dwordx4 a[52:55], v1, s[8:11], s68 offen nt
    s_addk_i32 s68, 1024
    s_and_b32 s68, s68, s69
    s_bitcmp1_b32 s6, 0
    s_cbranch_scc1 L_h_10
    s_sub_u32 s83, s70, 9
    s_mul_i32 s50, s83, 9363
    s_lshr_b32 s50, s50, 16
    s_mul_i32 s75, s50, 7
    s_sub_u32 s83, s83, s75
    s_cmp_gt_u32 s83, 2
    s_addc_u32 s83, s83, 0
    s_cmp_lt_u32 s70, 9
    s_cselect_b32 s50, s70, s50
    s_cselect_b32 s83, 3, s83
    s_lshl_b32 s50, s50, 3
    s_add_u32 s50, s50, s83
L_h_10:
    s_bitcmp1_b32 s6, 0
    s_cbranch_scc1 L_h_11
    s_lshl_b32 s58, s50, 7
    s_mul_i32 s83, s3, 73728
    s_add_u32 s58, s58, s83
    s_mul_i32 s83, s51, 2654208
    s_add_u32 s58, s58, s83
    s_mov_b32 s73, s58
    s_lshl_b32 s59, s50, 1
    s_add_u32 s59, s59, s51
    s_lshl_b32 s59, s59, 2
    s_add_u32 s59, s59, s3
    s_mul_i32 s59, s59, 9216
    s_lshl_b32 s83, s3, 10
    s_mov_b32 m0, s83
L_h_11:
    s_cmp_gt_u32 s72, 1
    s_cbranch_scc1 L_t_12
    s_waitcnt vmcnt(5)
L_t_12:
    buffer_load_dwordx4 a[56:59], v1, s[8:11], s68 offen nt
    s_addk_i32 s68, 1024
    s_and_b32 s68, s68, s69
    s_bitcmp1_b32 s6, 0
    s_cbranch_scc1 L_h_13
    s_movk_i32 s83, 9216
    v_mad_u32_u24 v6, v96, s83, v95
    s_movk_i32 s83, 1152
    v_mad_u32_u24 v3, v96, s83, v95
    v_bfe_u32 v97, v0, 1, 2
    v_mul_u32_u24 v97, 1152, v97
    v_bfe_u32 v98, v0, 5, 1
    v_lshl_add_u32 v97, v98, 6, v97
    v_bfe_u32 v98, v0, 3, 1
    v_lshl_add_u32 v97, v98, 5, v97
L_h_13:
    s_bitcmp1_b32 s6, 0
    s_cbranch_scc1 L_h_14
    v_and_b32 v98, 1, v0
    v_lshl_add_u32 v97, v98, 4, v97
    v_bfe_u32 v98, v0, 4, 1
    v_lshl_add_u32 v97, v98, 3, v97
    s_lshl_b32 s83, s3, 7
    s_mul_i32 s75, s51, 576
    s_add_u32 s83, s83, s75
    s_add_u32 s83, s83, 158464
    v_add_u32 v97, s83, v97
    ds_read_b64 v[192:193], v97
    ds_read_b64 v[194:195], v97 offset:512
L_h_14:
    s_cmp_gt_u32 s72, 2
    s_cbranch_scc1 L_t_15
    s_waitcnt vmcnt(5)
L_t_15:
    buffer_load_dwordx4 a[60:63], v1, s[8:11], s68 offen nt
    s_addk_i32 s68, 1024
    s_and_b32 s68, s68, s69
    s_bitcmp1_b32 s6, 0
    s_cbranch_scc1 L_h_16
    v_mov_b32 v184, 0x3f803f80
    v_mov_b32 v185, v184
    v_mov_b32 v186, v184
    v_mov_b32_e64 v187, v184
    v_mul_u32_u24 v97, 272, v0
    v_add_u32 v97, 147712, v97
    s_mov_b64 exec, 0x1ff
    ds_write_b128 v97, v[184:187]
    s_mov_b64 exec, -1
L_h_16:
    s_bitcmp1_b32 s6, 0
    s_cbranch_scc1 L_h_17
    v_mov_b32 v188, 0
    v_mov_b32 v189, 0
    v_mov_b32 v190, 0
    v_mov_b32 v191, 0
    v_mov_b32 v97, 157952
    ds_write_b128 v97, v[188:191]
L_h_17:
    s_cmp_gt_u32 s72, 3
    s_cbranch_scc1 L_t_18
    s_waitcnt vmcnt(5)
L_t_18:
    buffer_load_dwordx4 a[64:67], v1, s[8:11], s68 offen nt
    s_addk_i32 s68, 1024
    s_and_b32 s68, s68, s69
    s_bitcmp1_b32 s6, 0
    s_cbranch_scc1 L_h_19
    s_waitcnt lgkmcnt(0)
    s_cmp_eq_u32 s3, 0
    s_cselect_b32 s66, -1, 0
    s_mov_b32 s67, 0
    v_cndmask_b32 v194, 0, v194, s[66:67]
    v_cndmask_b32 v195, 0, v195, s[66:67]
    v_lshlrev_b32 v172, 16, v192
    v_and_b32 v173, s78, v192
    v_lshlrev_b32 v174, 16, v193
    v_and_b32 v175, s78, v193
    v_lshlrev_b32 v176, 16, v194
    v_and_b32 v177, s78, v194
    v_lshlrev_b32 v178, 16, v195
    v_and_b32 v179, s78, v195
L_h_19:
    s_bitcmp1_b32 s6, 0
    s_cbranch_scc1 L_h_20
    v_and_b32 v97, 1, v0
    v_cmp_eq_u32 s[66:67], 1, v97
    v_mov_b32 v98, 0x3f80
    v_mov_b32 v99, 0x3f800000
    v_cndmask_b32 v98, v98, v99, s[66:67]
    v_bfe_u32 v97, v0, 1, 3
L_h_20:
    s_cmp_gt_u32 s72, 4
    s_cbranch_scc1 L_t_21
    s_waitcnt vmcnt(5)
L_t_21:
    buffer_load_dwordx4 a[68:71], v1, s[8:11], s68 offen nt
    s_addk_i32 s68, 1024
    s_and_b32 s68, s68, s69
    s_bitcmp1_b32 s6, 0
    s_cbranch_scc1 L_h_22
    v_cmp_eq_u32 s[66:67], 0, v97
    s_nop 1
    v_cndmask_b32 v184, 0, v98, s[66:67]
    v_cmp_eq_u32 s[66:67], 1, v97
    s_nop 1
    v_cndmask_b32 v185, 0, v98, s[66:67]
    v_cmp_eq_u32 s[66:67], 2, v97
    s_nop 1
    v_cndmask_b32 v186, 0, v98, s[66:67]
    v_cmp_eq_u32 s[66:67], 3, v97
    s_nop 1
    v_cndmask_b32 v187, 0, v98, s[66:67]
L_h_22:
    s_bitcmp1_b32 s6, 0
    s_cbranch_scc1 L_h_23
    v_cmp_eq_u32 s[66:67], 4, v97
    s_nop 1
    v_cndmask_b32 v188, 0, v98, s[66:67]
    v_cmp_eq_u32 s[66:67], 5, v97
    s_nop 1
    v_cndmask_b32 v189, 0, v98, s[66:67]
    v_cmp_eq_u32 s[66:67], 6, v97
    s_nop 1
    v_cndmask_b32 v190, 0, v98, s[66:67]
    v_cmp_eq_u32 s[66:67], 7, v97
    s_nop 1
    v_cndmask_b32 v191, 0, v98, s[66:67]
L_h_23:
    s_cmp_gt_u32 s72, 5
    s_cbranch_scc1 L_t_24
    s_waitcnt vmcnt(5)
L_t_24:
    buffer_load_dwordx4 a[72:75], v1, s[8:11], s68 offen nt
    s_addk_i32 s68, 1024
    s_and_b32 s68, s68, s69
    s_bitcmp1_b32 s6, 0
    s_cbranch_scc1 L_h_25
    v_bfe_u32 v97, v0, 1, 2
    v_bfe_u32 v192, v0, 5, 1
    v_mul_u32_u24 v192, 272, v192
    v_bfe_u32 v98, v0, 3, 1
    v_lshl_add_u32 v192, v98, 7, v192
    v_and_b32_e64 v98, 1, v0
    v_lshl_add_u32 v192, v98, 6, v192
    v_lshl_add_u32 v192, v97, 4, v192
    v_bfe_u32 v98, v0, 4, 1
    v_lshl_add_u32 v192, v98, 3, v192
L_h_25:
    s_bitcmp1_b32 s6, 0
    s_cbranch_scc1 L_h_26
    s_mul_i32 s83, s3, 544
    s_add_u32 s83, s83, 147456
    v_add_u32 v192, s83, v192
    v_lshlrev_b32_e64 v193, 7, v97
    v_lshl_add_u32 v193, v93, 3, v193
    s_lshl_b32 s83, s3, 5
    s_add_u32 s83, s83, 156800
    v_add_u32 v193, s83, v193
L_h_26:
    s_cmp_gt_u32 s72, 6
    s_cbranch_scc1 L_t_27
    s_waitcnt vmcnt(5)
L_t_27:
    buffer_load_dwordx4 a[76:79], v1, s[8:11], s68 offen nt
    s_addk_i32 s68, 1024
    s_and_b32 s68, s68, s69
    s_bitcmp1_b32 s6, 0
    s_cbranch_scc1 L_h_28
    v_lshl_add_u32 v194, v93, 2, v92
    v_lshlrev_b32_e64 v194, 4, v194
    v_add_u32 v99, 157440, v194
    v_mov_b32 v98, 256
    v_cmp_eq_u32 s[66:67], 1, v94
    s_nop 1
    v_cndmask_b32 v194, v194, v98, s[66:67]
    v_add_u32 v194, 147456, v194
    v_lshlrev_b32 v195, 3, v0
    v_add_u32 v195, 156800, v195
L_h_28:
    s_cmp_gt_u32 s72, 7
    s_cbranch_scc1 L_t_29
    s_waitcnt vmcnt(5)
L_t_29:
    buffer_load_dwordx4 a[80:83], v1, s[8:11], s68 offen nt
    s_addk_i32 s68, 1024
    s_and_b32 s68, s68, s69
    s_bitcmp1_b32 s6, 0
    s_cbranch_scc1 L_h_30
    v_mov_b32 v98, 157952
    v_cmp_eq_u32 s[66:67], 0, v94
    s_nop 1
    v_cndmask_b32 v197, v98, v99, s[66:67]
    v_cmp_eq_u32 s[66:67], 1, v94
    s_nop 1
    v_cndmask_b32 v198, v98, v99, s[66:67]
    v_cmp_eq_u32 s[66:67], 2, v94
    s_nop 1
    v_cndmask_b32 v199, v98, v99, s[66:67]
    v_cmp_eq_u32 s[66:67], 3, v94
    s_nop 1
    v_cndmask_b32 v200, v98, v99, s[66:67]
L_h_30:
    s_cmp_gt_u32 s72, 8
    s_cbranch_scc1 L_t_31
    s_waitcnt vmcnt(5)
L_t_31:
    buffer_load_dwordx4 a[84:87], v1, s[8:11], s68 offen nt
    s_addk_i32 s68, 1024
    s_and_b32 s68, s68, s69
    s_bitcmp1_b32 s6, 0
    s_cbranch_scc1 L_h_32
    v_bfe_u32 v196, v0, 3, 1
    v_lshlrev_b32 v196, 6, v196
    v_lshl_add_u32 v196, v93, 4, v196
    v_and_b32 v98, 7, v0
    v_lshl_add_u32 v196, v98, 1, v196
    s_and_b32 s83, s3, 1
    s_lshl_b32 s83, s83, 7
    s_add_u32 s83, s83, 157440
    v_add_u32 v196, s83, v196
    v_mad_u32_u24 v98, v92, 3, v94
    v_lshrrev_b32 v203, 1, v98
    v_mul_u32_u24 v203, 18432, v203
    v_and_b32 v98, 1, v98
    v_lshl_add_u32 v203, v98, 6, v203
    v_lshl_add_u32 v203, v93, 4, v203
L_h_32:
    s_cmp_gt_u32 s72, 9
    s_cbranch_scc1 L_t_33
    s_waitcnt vmcnt(5)
L_t_33:
    buffer_load_dwordx4 a[88:91], v1, s[8:11], s68 offen nt
    s_addk_i32 s68, 1024
    s_and_b32 s68, s68, s69
    s_bitcmp1_b32 s6, 0
    s_cbranch_scc1 L_h_34
    v_bfe_u32 v97, v0, 5, 1
    v_lshlrev_b32_e64 v97, 6, v97
    v_lshl_add_u32 v97, v92, 4, v97
    v_bfe_u32 v98, v0, 4, 1
    v_lshl_add_u32 v97, v98, 3, v97
    v_add_u32 v97, 147456, v97
    s_mul_i32 s75, s51, 18
    s_cmp_eq_u32 s70, 0
    s_cselect_b32 s75, s75, 64
    s_mul_i32 s83, s3, 9
    s_sub_u32 s83, s83, s75
    v_add_u32 v98, s83, v94
    v_mov_b32 v183, 157952
    s_movk_i32 s83, 272
L_h_34:
    s_cmp_gt_u32 s72, 10
    s_cbranch_scc1 L_t_35
    s_waitcnt vmcnt(5)
L_t_35:
    buffer_load_dwordx4 a[92:95], v1, s[8:11], s68 offen nt
    s_addk_i32 s68, 1024
    s_and_b32 s68, s68, s69
    s_bitcmp1_b32 s6, 0
    s_cbranch_scc1 L_h_36
    v_and_b32 v99, 1, v98
    v_lshl_add_u32 v99, v99, 7, v97
    v_ashrrev_i32 v180, 1, v98
    v_mad_i32_i24 v180, v180, s83, v99
    v_cmp_gt_u32 s[66:67], 18, v98
    v_add_u32 v98, 3, v98
    s_nop 0
    v_cndmask_b32 v180, v183, v180, s[66:67]
L_h_36:
    s_cmp_gt_u32 s72, 11
    s_cbranch_scc1 L_t_37
    s_waitcnt vmcnt(5)
L_t_37:
    buffer_load_dwordx4 a[96:99], v1, s[8:11], s68 offen nt
    s_addk_i32 s68, 1024
    s_and_b32 s68, s68, s69
    s_bitcmp1_b32 s6, 0
    s_cbranch_scc1 L_h_38
    v_and_b32_e64 v99, 1, v98
    v_lshl_add_u32 v99, v99, 7, v97
    v_ashrrev_i32 v181, 1, v98
    v_mad_i32_i24 v181, v181, s83, v99
    v_cmp_gt_u32 s[66:67], 18, v98
    v_add_u32 v98, 3, v98
    s_nop 0
    v_cndmask_b32 v181, v183, v181, s[66:67]
L_h_38:
    s_cmp_gt_u32 s72, 12
    s_cbranch_scc1 L_t_39
    s_waitcnt vmcnt(5)
L_t_39:
    buffer_load_dwordx4 a[100:103], v1, s[8:11], s68 offen nt
    s_addk_i32 s68, 1024
    s_and_b32 s68, s68, s69
    s_bitcmp1_b32 s6, 0
    s_cbranch_scc1 L_h_40
    v_and_b32 v99, 1, v98
    v_lshl_add_u32 v99, v99, 7, v97
    v_ashrrev_i32 v182, 1, v98
    v_mad_i32_i24 v182, v182, s83, v99
    v_cmp_gt_u32 s[66:67], 18, v98
    v_add_u32 v98, 3, v98
    s_nop 0
    v_cndmask_b32 v182, v183, v182, s[66:67]
L_h_40:
    s_cmp_gt_u32 s72, 13
    s_cbranch_scc1 L_t_41
    s_waitcnt vmcnt(5)
L_t_41:
    buffer_load_dwordx4 a[104:107], v1, s[8:11], s68 offen nt
    s_addk_i32 s68, 1024
    s_and_b32 s68, s68, s69
    s_bitcmp1_b32 s6, 0
    s_cbranch_scc1 L_h_42
    s_lshl_b32 s83, s3, 5
    v_xor_b32 v97, s83, v4
    s_mul_i32 s75, s3, 9
    s_and_b32 s83, s75, 3
    s_lshl_b32 s83, s83, 5
    v_xor_b32 v248, s83, v97
    s_lshr_b32 s83, s75, 2
    s_lshl_b32 s83, s83, 12
    s_add_u32 s83, s83, 73728
    v_add_u32 v248, s83, v248
    s_add_u32 s75, s75, 1
    s_and_b32 s83, s75, 3
    s_lshl_b32 s83, s83, 5
    v_xor_b32 v249, s83, v97
    s_lshr_b32 s83, s75, 2
    s_lshl_b32 s83, s83, 12
    s_add_u32 s83, s83, 73728
    v_add_u32 v249, s83, v249
    s_add_u32 s75, s75, 1
    s_and_b32 s83, s75, 3
    s_lshl_b32 s83, s83, 5
    v_xor_b32 v250, s83, v97
    s_lshr_b32 s83, s75, 2
    s_lshl_b32 s83, s83, 12
    s_add_u32 s83, s83, 73728
    v_add_u32 v250, s83, v250
    s_add_u32 s75, s75, 1
    s_and_b32 s83, s75, 3
    s_lshl_b32 s83, s83, 5
    v_xor_b32_e64 v251, s83, v97
    s_lshr_b32 s83, s75, 2
    s_lshl_b32 s83, s83, 12
    s_add_u32 s83, s83, 73728
    v_add_u32_e64 v251, s83, v251
    s_add_u32 s75, s75, 1
L_h_42:
    s_cmp_gt_u32 s72, 14
    s_cbranch_scc1 L_t_43
    s_waitcnt vmcnt(5)
L_t_43:
    buffer_load_dwordx4 a[108:111], v1, s[8:11], s68 offen nt
    s_addk_i32 s68, 1024
    s_and_b32 s68, s68, s69
    s_bitcmp1_b32 s6, 0
    s_cbranch_scc1 L_h_44
    s_mul_i32 s83, s4, 1024
    s_add_u32 s83, s83, 1569792
    v_lshlrev_b32 v207, 7, v93
    v_add_u32_e64 v207, s83, v207
L_h_44:
    s_cmp_gt_u32 s72, 15
    s_cbranch_scc1 L_t_45
    s_waitcnt vmcnt(5)
L_t_45:
    buffer_load_dwordx4 a[112:115], v1, s[8:11], s68 offen nt
    s_addk_i32 s68, 1024
    s_and_b32 s68, s68, s69
    s_bitcmp1_b32 s6, 0
    s_cbranch_scc1 L_h_46
    s_mul_i32 s62, s3, 221184
    s_lshl_b32 s83, s2, 7
    s_add_u32 s62, s62, s83
    s_add_u32 s62, s62, 619520
    s_add_u32 s71, s62, 110592
    s_mul_i32 s65, s51, 18432
    s_add_u32 s65, s65, 581632
    s_lshl_b32 s63, s3, 12
    s_add_u32 s63, s63, s65
    s_add_u32 s65, s65, 16384
    s_lshl_b32 s61, s4, 7
    s_add_u32 s61, s61, 1635328
L_h_46:
    s_cmp_gt_u32 s72, 16
    s_cbranch_scc1 L_t_47
    s_waitcnt vmcnt(5)
L_t_47:
    buffer_load_dwordx4 a[116:119], v1, s[8:11], s68 offen nt
    s_addk_i32 s68, 1024
    s_and_b32 s68, s68, s69
    s_bitcmp1_b32 s6, 0
    s_cbranch_scc0 L_h_48
    s_lshl_b32 s82, s7, 2
    s_add_u32 s82, s82, s3
    s_and_b32 s51, s82, 1
    s_mul_i32 s51, s51, 3072
    s_lshr_b32 s82, s82, 1
    s_sub_u32 s83, s5, 27
    s_lshl_b32 s83, s83, 2
    s_add_u32 s83, s83, s3
    s_cmp_eq_u32 s6, 1
    s_cselect_b32 s82, s82, s83
    s_cselect_b32 s51, s51, 6144
    s_lshr_b32 s70, s82, 1
    s_lshl_b32 s70, s70, 3
    s_add_u32 s70, s70, s4
    s_sub_u32 s83, s70, 9
    s_mul_i32 s50, s83, 9363
    s_lshr_b32 s50, s50, 16
    s_mul_i32 s75, s50, 7
    s_sub_u32 s83, s83, s75
    s_cmp_gt_u32 s83, 2
    s_addc_u32 s83, s83, 0
    s_cmp_lt_u32 s70, 9
    s_cselect_b32 s50, s70, s50
    s_cselect_b32 s83, 3, s83
    s_lshl_b32 s50, s50, 3
    s_add_u32 s50, s50, s83
    s_and_b32 s83, s82, 1
    s_lshl_b32 s50, s50, 1
    s_add_u32 s50, s50, s83
    s_mul_i32 s50, s50, 36864
    s_add_u32 s50, s50, s51
    s_cmp_lt_u32 s82, 18
    s_cselect_b32 s50, s50, s26
    v_lshlrev_b32 v182, 7, v0
L_h_48:
    s_cmp_gt_u32 s72, 17
    s_cbranch_scc1 L_t_49
    s_waitcnt vmcnt(5)
L_t_49:
    buffer_load_dwordx4 a[120:123], v1, s[8:11], s68 offen nt
    s_addk_i32 s68, 1024
    s_and_b32 s68, s68, s69
    s_cmp_eq_u32 s6, 1
    s_cbranch_scc0 L_h_50
    v_and_b32 v97, 15, v0
    v_and_b32 v172, 7, v0
    v_xor_b32 v172, v172, v93
    v_lshlrev_b32 v172, 4, v172
    v_lshl_add_u32 v172, v97, 8, v172
    s_lshl_b32 s83, s3, 12
    s_add_u32 s83, s83, 73728
    v_add_u32 v172, s83, v172
    v_xor_b32 v173, 64, v172
    v_xor_b32 v174, v97, v93
    v_lshlrev_b32 v174, 4, v174
    v_lshl_add_u32 v174, v93, 8, v174
    v_add_u32 v174, 73728, v174
    v_xor_b32 v175, 64, v174
    v_lshlrev_b32 v176, 5, v92
    v_lshl_add_u32 v176, v93, 3, v176
    v_lshlrev_b32 v177, 7, v0
    v_lshlrev_b32 v178, 4, v97
    v_add_u32 v178, 156800, v178
    s_lshl_b32 s83, s3, 2
    v_add_u32 v179, s83, v178
    v_mov_b32 v180, 0
    v_mov_b32 v181, s54
L_h_50:
    s_cmp_gt_u32 s72, 18
    s_cbranch_scc1 L_t_51
    s_waitcnt vmcnt(5)
L_t_51:
    buffer_load_dwordx4 a[124:127], v1, s[8:11], s68 offen nt
    s_addk_i32 s68, 1024
    s_and_b32 s68, s68, s69
    s_cmp_eq_u32 s6, 1
    s_cbranch_scc0 L_h_52
    s_lshr_b32 s83, s3, 1
    s_lshl_b32 s62, s7, 1
    s_add_u32 s62, s62, s83
    s_lshl_b32 s62, s62, 3
    s_add_u32 s62, s62, s4
    s_lshl_b32 s62, s62, 1
    s_and_b32 s75, s3, 1
    s_add_u32 s62, s62, s75
    s_lshl_b32 s62, s62, 7
    s_add_u32 s62, s62, 581632
    s_lshl_b32 s63, s4, 2
    s_add_u32 s63, s63, s3
    s_lshl_b32 s63, s63, 12
    s_add_u32 s63, s63, 450560
    s_lshl_b32 s64, s4, 1
    s_add_u32 s64, s64, s83
    s_lshl_b32 s64, s64, 11
    s_lshl_b32 s75, s75, 3
    s_add_u32 s64, s64, s75
    s_add_u32 s64, s64, 417792
    s_lshl_b32 s61, s4, 7
    s_add_u32 s61, s61, 1569792
L_h_52:
    s_waitcnt vmcnt(5)
    buffer_load_dwordx4 a[128:131], v2, s[12:15], s68 offen nt
    s_addk_i32 s68, 1024
    s_and_b32 s68, s68, s69
    v_bfe_u32 v62, v0, 2, 1
    v_lshlrev_b32_e64 v62, 9, v62
    v_lshl_add_u32 v62, v93, 7, v62
    v_lshl_add_u32 v62, v94, 4, v62
    s_mul_i32 s83, s3, 1280
    s_add_u32 s83, s83, 99328
    v_mul_u32_u24 v63, 128, v0
    v_add_u32 v63, s83, v63
    s_lshl_b32 s56, s4, 5
    s_add_u32 s57, s56, s5
    s_xor_b32 s57, s57, 1
    s_lshl_b32 s57, s57, 7
    s_add_u32 s57, s57, 66560
    s_lshl_b32 s56, s56, 7
    s_add_u32 s56, s56, 64768
    s_mov_b32 exec_lo, 0
    v_lshlrev_b32 v63, 7, v0
    v_add_u32 v63, s56, v63
    s_mov_b32 exec_lo, -1
    v_writelane_b32 v63, s57, 63
    s_movk_i32 s40, 0x3ff
    s_cmp_eq_u32 s3, 0
    s_cselect_b32 s41, 0x1ff, 0
    s_bitset1_b32 s41, 31
    v_mov_b32 v61, s54
    s_lshr_b32 s82, s77, 2
    s_lshl_b32 s82, s82, 14
    s_lshl_b32 s83, s76, 10
    s_add_u32 s82, s82, s83
    s_mov_b32 s75, s82
    s_lshl_b32 s82, s4, 12
    s_add_u32 s82, s82, 1537024
    s_lshl_b32 s83, s3, 7
    s_add_u32 s83, s83, s82
    v_lshlrev_b32_e64 v253, 9, v0
    s_mov_b64 exec, 0xff
    buffer_load_dword v210, v253, s[20:23], s83 offen sc1
    s_mov_b64 exec, -1
    s_cmp_eq_u32 s3, 2
    s_cbranch_scc0 L_nm_53
    s_lshl_b32 s83, s5, 7
    s_add_u32 s82, s82, s83
    v_mov_b32 v97, s54
    v_lshlrev_b32_e64 v98, 2, v0
    s_mov_b32 exec_hi, 0
    buffer_store_dword v97, v98, s[20:23], s82 offen
    s_mov_b32 exec_hi, -1
L_nm_53:
    s_mov_b32 s82, s75
    s_mov_b64 exec, s[40:41]
    buffer_load_dword v61, v63, s[20:23], 0 offen sc1
    s_mov_b64 exec, -1
    buffer_load_dwordx4 v[52:55], v62, s[20:23], s82 offen sc1
    buffer_load_dwordx4 v[56:59], v62, s[20:23], s82 offen offset:64 sc1
    s_waitcnt vmcnt(5)
    buffer_load_dwordx4 a[132:135], v2, s[12:15], s68 offen nt
    s_addk_i32 s68, 1024
    s_and_b32 s68, s68, s69
    s_waitcnt vmcnt(5)
    buffer_load_dwordx4 a[136:139], v2, s[12:15], s68 offen nt
    s_addk_i32 s68, 1024
    s_and_b32 s68, s68, s69
    s_waitcnt vmcnt(5)
    buffer_load_dwordx4 a[140:143], v2, s[12:15], s68 offen nt
    s_addk_i32 s68, 1024
    s_and_b32 s68, s68, s69
    s_waitcnt vmcnt(5)
    buffer_load_dwordx4 a[144:147], v2, s[12:15], s68 offen nt
    s_addk_i32 s68, 1024
    s_and_b32 s68, s68, s69
    s_waitcnt vmcnt(5)
    buffer_load_dwordx4 a[148:151], v2, s[12:15], s68 offen nt
    s_addk_i32 s68, 1024
    s_and_b32 s68, s68, s69
    s_waitcnt vmcnt(5)
    buffer_load_dwordx4 a[152:155], v2, s[12:15], s68 offen nt
    s_addk_i32 s68, 1024
    s_and_b32 s68, s68, s69
    s_waitcnt vmcnt(5)
    buffer_load_dwordx4 a[156:159], v2, s[12:15], s68 offen nt
    s_addk_i32 s68, 1024
    s_and_b32 s68, s68, s69
    v_and_b32 v97, 1, v0
    v_cmp_eq_u32 vcc, 1, v97
    v_mov_b32 v98, 0xffff
    v_mov_b32 v99, s78
    v_cndmask_b32 v98, v98, v99, vcc
    v_bfe_u32 v97, v0, 3, 1
    v_bfe_u32 v99, v0, 1, 1
    v_lshl_or_b32 v97, v97, 1, v99
    v_cmp_eq_u32 vcc, 0, v97
    s_nop 1
    v_cndmask_b32 v12, 0, v98, vcc
    v_cmp_eq_u32 vcc, 1, v97
    s_nop 1
    v_cndmask_b32 v13, 0, v98, vcc
    v_cmp_eq_u32 vcc, 2, v97
    s_nop 1
    v_cndmask_b32 v14, 0, v98, vcc
    v_cmp_eq_u32 vcc, 3, v97
    s_nop 1
    v_cndmask_b32 v15, 0, v98, vcc
    v_mov_b32 v7, 0xff800000
    s_mov_b32 s81, 0
    s_waitcnt vmcnt(7)
    s_branch L_qchk
L_qpoll:
    s_mov_b64 exec, s[40:41]
    buffer_load_dword v61, v63, s[20:23], 0 offen sc1
    s_mov_b64 exec, -1
    buffer_load_dwordx4 v[52:55], v62, s[20:23], s82 offen sc1
    buffer_load_dwordx4 v[56:59], v62, s[20:23], s82 offen offset:64 sc1
    s_add_u32 s81, s81, 1
    s_cmp_gt_u32 s81, 2097152
    s_waitcnt vmcnt(0)
    s_cbranch_scc1 L_qgo
L_qchk:
    v_mov_b32 v60, 0
    s_mov_b32 exec_hi, 0
    v_xor_b32 v60, s54, v61
    s_mov_b32 exec_hi, -1
    v_xor_b32 v53, s54, v53
    v_xor_b32 v55, s54, v55
    v_xor_b32 v57, s54, v57
    v_xor_b32 v59, s54, v59
    v_or3_b32 v60, v60, v53, v55
    v_or3_b32 v60, v60, v57, v59
    v_cmp_ne_u32 vcc, 0, v60
    s_cbranch_vccnz L_qpoll
L_qgo:
    v_cmp_ne_u32 vcc, s43, v61
    v_mov_b32 v8, v52
    v_mov_b32 v9, v54
    v_mov_b32 v10, v56
    v_mov_b32_e64 v11, v58
    s_and_b32 s55, vcc_hi, 0x1ff
    s_cselect_b32 s55, 0, 1
    s_bitcmp0_b32 vcc_hi, 31
    s_cselect_b32 s49, 1, 0
    s_mov_b64 exec, 0xff
    v_cmp_eq_u32 vcc, s54, v210
    s_mov_b64 exec, -1
    s_bcnt1_i32_b32 s82, vcc_lo
    s_cmp_ge_u32 s72, 40
    s_cselect_b32 s82, 16, s82
    s_mov_b32 s74, s82
    s_cmp_ge_u32 s82, 4
    s_cselect_b64 vcc, -1, 0
    v_mfma_f32_16x16x32_bf16 v[52:55], a[0:3], v[8:11], 0
    v_mfma_f32_16x16x32_bf16 v[56:59], a[4:7], v[8:11], 0
    v_mfma_f32_16x16x32_bf16 v[60:63], a[8:11], v[8:11], 0
    v_mfma_f32_16x16x32_bf16 v[64:67], a[12:15], v[8:11], 0
    v_mfma_f32_16x16x32_bf16 v[68:71], a[16:19], v[8:11], 0
    v_mfma_f32_16x16x32_bf16 v[72:75], a[20:23], v[8:11], 0
    v_mfma_f32_16x16x32_bf16 v[76:79], a[24:27], v[8:11], 0
    v_mfma_f32_16x16x32_bf16 v[80:83], a[28:31], v[8:11], 0
    s_nop 0
    v_mov_b32_dpp v20, v52 quad_perm:[0,0,0,0] row_mask:0xf bank_mask:0xf
    v_mov_b32_dpp v21, v56 quad_perm:[0,0,0,0] row_mask:0xf bank_mask:0xf
    v_mov_b32_dpp v22, v60 quad_perm:[0,0,0,0] row_mask:0xf bank_mask:0xf
    v_mov_b32_dpp v23, v64 quad_perm:[0,0,0,0] row_mask:0xf bank_mask:0xf
    v_add_f32_dpp v20, v53, v20 quad_perm:[1,1,1,1] row_mask:0xf bank_mask:0xf
    v_add_f32_dpp v21, v57, v21 quad_perm:[1,1,1,1] row_mask:0xf bank_mask:0xf
    v_add_f32_dpp v22, v61, v22 quad_perm:[1,1,1,1] row_mask:0xf bank_mask:0xf
    v_add_f32_dpp v23, v65, v23 quad_perm:[1,1,1,1] row_mask:0xf bank_mask:0xf
    v_add_f32_dpp v20, v54, v20 quad_perm:[2,2,2,2] row_mask:0xf bank_mask:0xf
    v_add_f32_dpp v21, v58, v21 quad_perm:[2,2,2,2] row_mask:0xf bank_mask:0xf
    v_add_f32_dpp v22, v62, v22 quad_perm:[2,2,2,2] row_mask:0xf bank_mask:0xf
    v_add_f32_dpp v23, v66, v23 quad_perm:[2,2,2,2] row_mask:0xf bank_mask:0xf
    v_add_f32_dpp v20, v55, v20 quad_perm:[3,3,3,3] row_mask:0xf bank_mask:0xf
    v_add_f32_dpp v21, v59, v21 quad_perm:[3,3,3,3] row_mask:0xf bank_mask:0xf
    v_add_f32_dpp v22, v63, v22 quad_perm:[3,3,3,3] row_mask:0xf bank_mask:0xf
    v_add_f32_dpp v23, v67, v23 quad_perm:[3,3,3,3] row_mask:0xf bank_mask:0xf
    v_max3_f32 v7, v20, v21, v7
    v_max3_f32 v7, v22, v23, v7
    v_cvt_pk_bf16_f32 v97, v20, v21
    v_cvt_pk_bf16_f32 v98, v22, v23
    v_lshlrev_b32 v20, 16, v97
    v_and_b32 v21, s78, v97
    v_lshlrev_b32 v22, 16, v98
    v_and_b32 v23, s78, v98
    v_mul_f32 v20, s79, v20
    v_mul_f32 v21, s79, v21
    v_mul_f32 v22, s79, v22
    v_mul_f32 v23, s79, v23
    v_cvt_pk_bf16_f32 v97, v20, v21
    v_cvt_pk_bf16_f32 v98, v22, v23
    v_lshlrev_b32 v20, 16, v97
    v_and_b32 v21, s78, v97
    v_lshlrev_b32 v22, 16, v98
    v_and_b32 v23, s78, v98
    s_cbranch_vccnz L_t_54
    s_waitcnt vmcnt(5)
L_t_54:
    buffer_load_dwordx4 a[160:163], v2, s[12:15], s68 offen nt
    s_addk_i32 s68, 1024
    s_and_b32 s68, s68, s69
    v_mfma_f32_16x16x32_bf16 v[52:55], a[32:35], v[8:11], 0
    v_mfma_f32_16x16x32_bf16 v[56:59], a[36:39], v[8:11], 0
    v_mfma_f32_16x16x32_bf16 v[60:63], a[40:43], v[8:11], 0
    v_mfma_f32_16x16x32_bf16 v[64:67], a[44:47], v[8:11], 0
    v_mov_b32_dpp v24, v68 quad_perm:[0,0,0,0] row_mask:0xf bank_mask:0xf
    v_mov_b32_dpp v25, v72 quad_perm:[0,0,0,0] row_mask:0xf bank_mask:0xf
    v_mov_b32_dpp v26, v76 quad_perm:[0,0,0,0] row_mask:0xf bank_mask:0xf
    v_mov_b32_dpp v27, v80 quad_perm:[0,0,0,0] row_mask:0xf bank_mask:0xf
    v_add_f32_dpp v24, v69, v24 quad_perm:[1,1,1,1] row_mask:0xf bank_mask:0xf
    v_add_f32_dpp v25, v73, v25 quad_perm:[1,1,1,1] row_mask:0xf bank_mask:0xf
    v_add_f32_dpp v26, v77, v26 quad_perm:[1,1,1,1] row_mask:0xf bank_mask:0xf
    v_add_f32_dpp v27, v81, v27 quad_perm:[1,1,1,1] row_mask:0xf bank_mask:0xf
    v_add_f32_dpp v24, v70, v24 quad_perm:[2,2,2,2] row_mask:0xf bank_mask:0xf
    v_add_f32_dpp v25, v74, v25 quad_perm:[2,2,2,2] row_mask:0xf bank_mask:0xf
    v_add_f32_dpp v26, v78, v26 quad_perm:[2,2,2,2] row_mask:0xf bank_mask:0xf
    v_add_f32_dpp v27, v82, v27 quad_perm:[2,2,2,2] row_mask:0xf bank_mask:0xf
    v_add_f32_dpp v24, v71, v24 quad_perm:[3,3,3,3] row_mask:0xf bank_mask:0xf
    v_add_f32_dpp v25, v75, v25 quad_perm:[3,3,3,3] row_mask:0xf bank_mask:0xf
    v_add_f32_dpp v26, v79, v26 quad_perm:[3,3,3,3] row_mask:0xf bank_mask:0xf
    v_add_f32_dpp v27, v83, v27 quad_perm:[3,3,3,3] row_mask:0xf bank_mask:0xf
    v_max3_f32 v7, v24, v25, v7
    v_max3_f32 v7, v26, v27, v7
    v_cvt_pk_bf16_f32 v97, v24, v25
    v_cvt_pk_bf16_f32 v98, v26, v27
    v_lshlrev_b32 v24, 16, v97
    v_and_b32 v25, s78, v97
    v_lshlrev_b32 v26, 16, v98
    v_and_b32 v27, s78, v98
    v_mul_f32 v24, s79, v24
    v_mul_f32 v25, s79, v25
    v_mul_f32 v26, s79, v26
    v_mul_f32 v27, s79, v27
    v_cvt_pk_bf16_f32 v97, v24, v25
    v_cvt_pk_bf16_f32 v98, v26, v27
    v_lshlrev_b32 v24, 16, v97
    v_and_b32 v25, s78, v97
    v_lshlrev_b32 v26, 16, v98
    v_and_b32 v27, s78, v98
    s_cbranch_vccnz L_t_55
    s_waitcnt vmcnt(5)
L_t_55:
    buffer_load_dwordx4 a[164:167], v2, s[12:15], s68 offen nt
    s_addk_i32 s68, 1024
    s_and_b32 s68, s68, s69
    v_mfma_f32_16x16x32_bf16 v[68:71], a[48:51], v[8:11], 0
    v_mfma_f32_16x16x32_bf16 v[72:75], a[52:55], v[8:11], 0
    v_mfma_f32_16x16x32_bf16 v[76:79], a[56:59], v[8:11], 0
    v_mfma_f32_16x16x32_bf16 v[80:83], a[60:63], v[8:11], 0
    v_mov_b32_dpp v28, v52 quad_perm:[0,0,0,0] row_mask:0xf bank_mask:0xf
    v_mov_b32_dpp v29, v56 quad_perm:[0,0,0,0] row_mask:0xf bank_mask:0xf
    v_mov_b32_dpp v30, v60 quad_perm:[0,0,0,0] row_mask:0xf bank_mask:0xf
    v_mov_b32_dpp v31, v64 quad_perm:[0,0,0,0] row_mask:0xf bank_mask:0xf
    v_add_f32_dpp v28, v53, v28 quad_perm:[1,1,1,1] row_mask:0xf bank_mask:0xf
    v_add_f32_dpp v29, v57, v29 quad_perm:[1,1,1,1] row_mask:0xf bank_mask:0xf
    v_add_f32_dpp v30, v61, v30 quad_perm:[1,1,1,1] row_mask:0xf bank_mask:0xf
    v_add_f32_dpp v31, v65, v31 quad_perm:[1,1,1,1] row_mask:0xf bank_mask:0xf
    v_add_f32_dpp v28, v54, v28 quad_perm:[2,2,2,2] row_mask:0xf bank_mask:0xf
    v_add_f32_dpp v29, v58, v29 quad_perm:[2,2,2,2] row_mask:0xf bank_mask:0xf
    v_add_f32_dpp v30, v62, v30 quad_perm:[2,2,2,2] row_mask:0xf bank_mask:0xf
    v_add_f32_dpp v31, v66, v31 quad_perm:[2,2,2,2] row_mask:0xf bank_mask:0xf
    v_add_f32_dpp v28, v55, v28 quad_perm:[3,3,3,3] row_mask:0xf bank_mask:0xf
    v_add_f32_dpp v29, v59, v29 quad_perm:[3,3,3,3] row_mask:0xf bank_mask:0xf
    v_add_f32_dpp v30, v63, v30 quad_perm:[3,3,3,3] row_mask:0xf bank_mask:0xf
    v_add_f32_dpp v31, v67, v31 quad_perm:[3,3,3,3] row_mask:0xf bank_mask:0xf
    v_max3_f32 v7, v28, v29, v7
    v_max3_f32 v7, v30, v31, v7
    v_cvt_pk_bf16_f32 v97, v28, v29
    v_cvt_pk_bf16_f32 v98, v30, v31
    v_lshlrev_b32 v28, 16, v97
    v_and_b32 v29, s78, v97
    v_lshlrev_b32 v30, 16, v98
    v_and_b32 v31, s78, v98
    v_mul_f32 v28, s79, v28
    v_mul_f32 v29, s79, v29
    v_mul_f32 v30, s79, v30
    v_mul_f32 v31, s79, v31
    v_cvt_pk_bf16_f32 v97, v28, v29
    v_cvt_pk_bf16_f32 v98, v30, v31
    v_lshlrev_b32 v28, 16, v97
    v_and_b32 v29, s78, v97
    v_lshlrev_b32 v30, 16, v98
    v_and_b32 v31, s78, v98
    s_cbranch_vccnz L_t_56
    s_waitcnt vmcnt(5)
L_t_56:
    buffer_load_dwordx4 a[168:171], v2, s[12:15], s68 offen nt
    s_addk_i32 s68, 1024
    s_and_b32 s68, s68, s69
    v_mfma_f32_16x16x32_bf16 v[52:55], a[64:67], v[8:11], 0
    v_mfma_f32_16x16x32_bf16 v[56:59], a[68:71], v[8:11], 0
    v_mfma_f32_16x16x32_bf16 v[60:63], a[72:75], v[8:11], 0
    v_mfma_f32_16x16x32_bf16 v[64:67], a[76:79], v[8:11], 0
    v_mov_b32_dpp v32, v68 quad_perm:[0,0,0,0] row_mask:0xf bank_mask:0xf
    v_mov_b32_dpp v33, v72 quad_perm:[0,0,0,0] row_mask:0xf bank_mask:0xf
    v_mov_b32_dpp v34, v76 quad_perm:[0,0,0,0] row_mask:0xf bank_mask:0xf
    v_mov_b32_dpp v35, v80 quad_perm:[0,0,0,0] row_mask:0xf bank_mask:0xf
    v_add_f32_dpp v32, v69, v32 quad_perm:[1,1,1,1] row_mask:0xf bank_mask:0xf
    v_add_f32_dpp v33, v73, v33 quad_perm:[1,1,1,1] row_mask:0xf bank_mask:0xf
    v_add_f32_dpp v34, v77, v34 quad_perm:[1,1,1,1] row_mask:0xf bank_mask:0xf
    v_add_f32_dpp v35, v81, v35 quad_perm:[1,1,1,1] row_mask:0xf bank_mask:0xf
    v_add_f32_dpp v32, v70, v32 quad_perm:[2,2,2,2] row_mask:0xf bank_mask:0xf
    v_add_f32_dpp v33, v74, v33 quad_perm:[2,2,2,2] row_mask:0xf bank_mask:0xf
    v_add_f32_dpp v34, v78, v34 quad_perm:[2,2,2,2] row_mask:0xf bank_mask:0xf
    v_add_f32_dpp v35, v82, v35 quad_perm:[2,2,2,2] row_mask:0xf bank_mask:0xf
    v_add_f32_dpp v32, v71, v32 quad_perm:[3,3,3,3] row_mask:0xf bank_mask:0xf
    v_add_f32_dpp v33, v75, v33 quad_perm:[3,3,3,3] row_mask:0xf bank_mask:0xf
    v_add_f32_dpp v34, v79, v34 quad_perm:[3,3,3,3] row_mask:0xf bank_mask:0xf
    v_add_f32_dpp v35, v83, v35 quad_perm:[3,3,3,3] row_mask:0xf bank_mask:0xf
    v_max3_f32 v7, v32, v33, v7
    v_max3_f32 v7, v34, v35, v7
    v_cvt_pk_bf16_f32 v97, v32, v33
    v_cvt_pk_bf16_f32 v98, v34, v35
    v_lshlrev_b32 v32, 16, v97
    v_and_b32 v33, s78, v97
    v_lshlrev_b32 v34, 16, v98
    v_and_b32 v35, s78, v98
    v_mul_f32 v32, s79, v32
    v_mul_f32 v33, s79, v33
    v_mul_f32 v34, s79, v34
    v_mul_f32 v35, s79, v35
    v_cvt_pk_bf16_f32 v97, v32, v33
    v_cvt_pk_bf16_f32 v98, v34, v35
    v_lshlrev_b32 v32, 16, v97
    v_and_b32 v33, s78, v97
    v_lshlrev_b32 v34, 16, v98
    v_and_b32 v35, s78, v98
    s_cbranch_vccnz L_t_57
    s_waitcnt vmcnt(5)
L_t_57:
    buffer_load_dwordx4 a[172:175], v2, s[12:15], s68 offen nt
    s_addk_i32 s68, 1024
    s_and_b32 s68, s68, s69
    v_mfma_f32_16x16x32_bf16 v[68:71], a[80:83], v[8:11], 0
    v_mfma_f32_16x16x32_bf16 v[72:75], a[84:87], v[8:11], 0
    v_mfma_f32_16x16x32_bf16 v[76:79], a[88:91], v[8:11], 0
    v_mfma_f32_16x16x32_bf16 v[80:83], a[92:95], v[8:11], 0
    v_mov_b32_dpp v36, v52 quad_perm:[0,0,0,0] row_mask:0xf bank_mask:0xf
    v_mov_b32_dpp v37, v56 quad_perm:[0,0,0,0] row_mask:0xf bank_mask:0xf
    v_mov_b32_dpp v38, v60 quad_perm:[0,0,0,0] row_mask:0xf bank_mask:0xf
    v_mov_b32_dpp v39, v64 quad_perm:[0,0,0,0] row_mask:0xf bank_mask:0xf
    v_add_f32_dpp v36, v53, v36 quad_perm:[1,1,1,1] row_mask:0xf bank_mask:0xf
    v_add_f32_dpp v37, v57, v37 quad_perm:[1,1,1,1] row_mask:0xf bank_mask:0xf
    v_add_f32_dpp v38, v61, v38 quad_perm:[1,1,1,1] row_mask:0xf bank_mask:0xf
    v_add_f32_dpp v39, v65, v39 quad_perm:[1,1,1,1] row_mask:0xf bank_mask:0xf
    v_add_f32_dpp v36, v54, v36 quad_perm:[2,2,2,2] row_mask:0xf bank_mask:0xf
    v_add_f32_dpp v37, v58, v37 quad_perm:[2,2,2,2] row_mask:0xf bank_mask:0xf
    v_add_f32_dpp v38, v62, v38 quad_perm:[2,2,2,2] row_mask:0xf bank_mask:0xf
    v_add_f32_dpp v39, v66, v39 quad_perm:[2,2,2,2] row_mask:0xf bank_mask:0xf
    v_add_f32_dpp v36, v55, v36 quad_perm:[3,3,3,3] row_mask:0xf bank_mask:0xf
    v_add_f32_dpp v37, v59, v37 quad_perm:[3,3,3,3] row_mask:0xf bank_mask:0xf
    v_add_f32_dpp v38, v63, v38 quad_perm:[3,3,3,3] row_mask:0xf bank_mask:0xf
    v_add_f32_dpp v39, v67, v39 quad_perm:[3,3,3,3] row_mask:0xf bank_mask:0xf
    v_max3_f32 v7, v36, v37, v7
    v_max3_f32 v7, v38, v39, v7
    v_cvt_pk_bf16_f32 v97, v36, v37
    v_cvt_pk_bf16_f32 v98, v38, v39
    v_lshlrev_b32 v36, 16, v97
    v_and_b32 v37, s78, v97
    v_lshlrev_b32 v38, 16, v98
    v_and_b32 v39, s78, v98
    v_mul_f32 v36, s79, v36
    v_mul_f32 v37, s79, v37
    v_mul_f32 v38, s79, v38
    v_mul_f32 v39, s79, v39
    v_cvt_pk_bf16_f32 v97, v36, v37
    v_cvt_pk_bf16_f32 v98, v38, v39
    v_lshlrev_b32 v36, 16, v97
    v_and_b32 v37, s78, v97
    v_lshlrev_b32 v38, 16, v98
    v_and_b32 v39, s78, v98
    s_cbranch_vccnz L_t_58
    s_waitcnt vmcnt(5)
L_t_58:
    buffer_load_dwordx4 a[176:179], v2, s[12:15], s68 offen nt
    s_addk_i32 s68, 1024
    s_and_b32 s68, s68, s69
    v_mfma_f32_16x16x32_bf16 v[52:55], a[96:99], v[8:11], 0
    v_mfma_f32_16x16x32_bf16 v[56:59], a[100:103], v[8:11], 0
    v_mfma_f32_16x16x32_bf16 v[60:63], a[104:107], v[8:11], 0
    v_mfma_f32_16x16x32_bf16 v[64:67], a[108:111], v[8:11], 0
    v_mov_b32_dpp v40, v68 quad_perm:[0,0,0,0] row_mask:0xf bank_mask:0xf
    v_mov_b32_dpp v41, v72 quad_perm:[0,0,0,0] row_mask:0xf bank_mask:0xf
    v_mov_b32_dpp v42, v76 quad_perm:[0,0,0,0] row_mask:0xf bank_mask:0xf
    v_mov_b32_dpp v43, v80 quad_perm:[0,0,0,0] row_mask:0xf bank_mask:0xf
    v_add_f32_dpp v40, v69, v40 quad_perm:[1,1,1,1] row_mask:0xf bank_mask:0xf
    v_add_f32_dpp v41, v73, v41 quad_perm:[1,1,1,1] row_mask:0xf bank_mask:0xf
    v_add_f32_dpp v42, v77, v42 quad_perm:[1,1,1,1] row_mask:0xf bank_mask:0xf
    v_add_f32_dpp v43, v81, v43 quad_perm:[1,1,1,1] row_mask:0xf bank_mask:0xf
    v_add_f32_dpp v40, v70, v40 quad_perm:[2,2,2,2] row_mask:0xf bank_mask:0xf
    v_add_f32_dpp v41, v74, v41 quad_perm:[2,2,2,2] row_mask:0xf bank_mask:0xf
    v_add_f32_dpp v42, v78, v42 quad_perm:[2,2,2,2] row_mask:0xf bank_mask:0xf
    v_add_f32_dpp v43, v82, v43 quad_perm:[2,2,2,2] row_mask:0xf bank_mask:0xf
    v_add_f32_dpp v40, v71, v40 quad_perm:[3,3,3,3] row_mask:0xf bank_mask:0xf
    v_add_f32_dpp v41, v75, v41 quad_perm:[3,3,3,3] row_mask:0xf bank_mask:0xf
    v_add_f32_dpp v42, v79, v42 quad_perm:[3,3,3,3] row_mask:0xf bank_mask:0xf
    v_add_f32_dpp v43, v83, v43 quad_perm:[3,3,3,3] row_mask:0xf bank_mask:0xf
    v_max3_f32 v7, v40, v41, v7
    v_max3_f32 v7, v42, v43, v7
    v_cvt_pk_bf16_f32 v97, v40, v41
    v_cvt_pk_bf16_f32 v98, v42, v43
    v_lshlrev_b32 v40, 16, v97
    v_and_b32 v41, s78, v97
    v_lshlrev_b32 v42, 16, v98
    v_and_b32 v43, s78, v98
    v_mul_f32 v40, s79, v40
    v_mul_f32 v41, s79, v41
    v_mul_f32 v42, s79, v42
    v_mul_f32 v43, s79, v43
    v_cvt_pk_bf16_f32 v97, v40, v41
    v_cvt_pk_bf16_f32 v98, v42, v43
    v_lshlrev_b32 v40, 16, v97
    v_and_b32 v41, s78, v97
    v_lshlrev_b32 v42, 16, v98
    v_and_b32 v43, s78, v98
    s_cbranch_vccnz L_t_59
    s_waitcnt vmcnt(5)
L_t_59:
    buffer_load_dwordx4 a[180:183], v2, s[12:15], s68 offen nt
    s_addk_i32 s68, 1024
    s_and_b32 s68, s68, s69
    v_mfma_f32_16x16x32_bf16 v[68:71], a[112:115], v[8:11], 0
    v_mfma_f32_16x16x32_bf16 v[72:75], a[116:119], v[8:11], 0
    v_mfma_f32_16x16x32_bf16 v[76:79], a[120:123], v[8:11], 0
    v_mfma_f32_16x16x32_bf16 v[80:83], a[124:127], v[8:11], 0
    v_mov_b32_dpp v44, v52 quad_perm:[0,0,0,0] row_mask:0xf bank_mask:0xf
    v_mov_b32_dpp v45, v56 quad_perm:[0,0,0,0] row_mask:0xf bank_mask:0xf
    v_mov_b32_dpp v46, v60 quad_perm:[0,0,0,0] row_mask:0xf bank_mask:0xf
    v_mov_b32_dpp v47, v64 quad_perm:[0,0,0,0] row_mask:0xf bank_mask:0xf
    v_add_f32_dpp v44, v53, v44 quad_perm:[1,1,1,1] row_mask:0xf bank_mask:0xf
    v_add_f32_dpp v45, v57, v45 quad_perm:[1,1,1,1] row_mask:0xf bank_mask:0xf
    v_add_f32_dpp v46, v61, v46 quad_perm:[1,1,1,1] row_mask:0xf bank_mask:0xf
    v_add_f32_dpp v47, v65, v47 quad_perm:[1,1,1,1] row_mask:0xf bank_mask:0xf
    v_add_f32_dpp v44, v54, v44 quad_perm:[2,2,2,2] row_mask:0xf bank_mask:0xf
    v_add_f32_dpp v45, v58, v45 quad_perm:[2,2,2,2] row_mask:0xf bank_mask:0xf
    v_add_f32_dpp v46, v62, v46 quad_perm:[2,2,2,2] row_mask:0xf bank_mask:0xf
    v_add_f32_dpp v47, v66, v47 quad_perm:[2,2,2,2] row_mask:0xf bank_mask:0xf
    v_add_f32_dpp v44, v55, v44 quad_perm:[3,3,3,3] row_mask:0xf bank_mask:0xf
    v_add_f32_dpp v45, v59, v45 quad_perm:[3,3,3,3] row_mask:0xf bank_mask:0xf
    v_add_f32_dpp v46, v63, v46 quad_perm:[3,3,3,3] row_mask:0xf bank_mask:0xf
    v_add_f32_dpp v47, v67, v47 quad_perm:[3,3,3,3] row_mask:0xf bank_mask:0xf
    v_max3_f32 v7, v44, v45, v7
    v_max3_f32 v7, v46, v47, v7
    v_cvt_pk_bf16_f32 v97, v44, v45
    v_cvt_pk_bf16_f32 v98, v46, v47
    v_lshlrev_b32 v44, 16, v97
    v_and_b32 v45, s78, v97
    v_lshlrev_b32 v46, 16, v98
    v_and_b32 v47, s78, v98
    v_mul_f32 v44, s79, v44
    v_mul_f32 v45, s79, v45
    v_mul_f32 v46, s79, v46
    v_mul_f32 v47, s79, v47
    v_cvt_pk_bf16_f32 v97, v44, v45
    v_cvt_pk_bf16_f32 v98, v46, v47
    v_lshlrev_b32 v44, 16, v97
    v_and_b32 v45, s78, v97
    v_lshlrev_b32 v46, 16, v98
    v_and_b32 v47, s78, v98
    s_cbranch_vccnz L_t_60
    s_waitcnt vmcnt(5)
L_t_60:
    buffer_load_dwordx4 a[184:187], v2, s[12:15], s68 offen nt
    s_addk_i32 s68, 1024
    s_and_b32 s68, s68, s69
    v_mov_b32_dpp v48, v68 quad_perm:[0,0,0,0] row_mask:0xf bank_mask:0xf
    v_mov_b32_dpp v49, v72 quad_perm:[0,0,0,0] row_mask:0xf bank_mask:0xf
    v_mov_b32_dpp v50, v76 quad_perm:[0,0,0,0] row_mask:0xf bank_mask:0xf
    v_mov_b32_dpp v51, v80 quad_perm:[0,0,0,0] row_mask:0xf bank_mask:0xf
    v_add_f32_dpp v48, v69, v48 quad_perm:[1,1,1,1] row_mask:0xf bank_mask:0xf
    v_add_f32_dpp v49, v73, v49 quad_perm:[1,1,1,1] row_mask:0xf bank_mask:0xf
    v_add_f32_dpp v50, v77, v50 quad_perm:[1,1,1,1] row_mask:0xf bank_mask:0xf
    v_add_f32_dpp v51, v81, v51 quad_perm:[1,1,1,1] row_mask:0xf bank_mask:0xf
    v_add_f32_dpp v48, v70, v48 quad_perm:[2,2,2,2] row_mask:0xf bank_mask:0xf
    v_add_f32_dpp v49, v74, v49 quad_perm:[2,2,2,2] row_mask:0xf bank_mask:0xf
    v_add_f32_dpp v50, v78, v50 quad_perm:[2,2,2,2] row_mask:0xf bank_mask:0xf
    v_add_f32_dpp v51, v82, v51 quad_perm:[2,2,2,2] row_mask:0xf bank_mask:0xf
    v_add_f32_dpp v48, v71, v48 quad_perm:[3,3,3,3] row_mask:0xf bank_mask:0xf
    v_add_f32_dpp v49, v75, v49 quad_perm:[3,3,3,3] row_mask:0xf bank_mask:0xf
    v_add_f32_dpp v50, v79, v50 quad_perm:[3,3,3,3] row_mask:0xf bank_mask:0xf
    v_add_f32_dpp v51, v83, v51 quad_perm:[3,3,3,3] row_mask:0xf bank_mask:0xf
    v_max3_f32 v7, v48, v49, v7
    v_max3_f32 v7, v50, v51, v7
    v_cvt_pk_bf16_f32 v97, v48, v49
    v_cvt_pk_bf16_f32 v98, v50, v51
    v_lshlrev_b32 v48, 16, v97
    v_and_b32 v49, s78, v97
    v_lshlrev_b32 v50, 16, v98
    v_and_b32 v51, s78, v98
    v_mul_f32 v48, s79, v48
    v_mul_f32 v49, s79, v49
    v_mul_f32 v50, s79, v50
    v_mul_f32 v51, s79, v51
    v_cvt_pk_bf16_f32 v97, v48, v49
    v_cvt_pk_bf16_f32 v98, v50, v51
    v_lshlrev_b32 v48, 16, v97
    v_and_b32 v49, s78, v97
    v_lshlrev_b32 v50, 16, v98
    v_and_b32 v51, s78, v98
    s_cbranch_vccnz L_t_61
    s_waitcnt vmcnt(5)
L_t_61:
    buffer_load_dwordx4 a[188:191], v2, s[12:15], s68 offen nt
    s_addk_i32 s68, 1024
    s_and_b32 s68, s68, s69
    v_mov_b32 v97, v7
    s_nop 1
    v_permlane16_swap_b32 v7, v97
    v_max_f32 v7, v7, v97
    v_mov_b32 v97, v7
    s_nop 1
    v_permlane32_swap_b32 v7, v97
    v_max_f32 v7, v7, v97
    v_cvt_pk_bf16_f32 v7, v7, v7
    v_and_b32 v7, s78, v7
    v_mul_f32 v7, s79, v7
    v_cvt_pk_bf16_f32 v7, v7, v7
    v_and_b32 v7, s78, v7
    v_mul_f32 v52, s80, v7
    v_fma_f32 v20, v20, s80, -v52
    v_fma_f32 v21, v21, s80, -v52
    v_fma_f32 v22, v22, s80, -v52
    v_fma_f32 v23, v23, s80, -v52
    v_fma_f32 v24, v24, s80, -v52
    v_fma_f32 v25, v25, s80, -v52
    v_fma_f32 v26, v26, s80, -v52
    v_fma_f32 v27, v27, s80, -v52
    v_fma_f32 v28, v28, s80, -v52
    v_fma_f32 v29, v29, s80, -v52
    v_fma_f32 v30, v30, s80, -v52
    v_fma_f32 v31, v31, s80, -v52
    v_fma_f32 v32, v32, s80, -v52
    v_fma_f32 v33, v33, s80, -v52
    v_fma_f32 v34, v34, s80, -v52
    v_fma_f32 v35, v35, s80, -v52
    v_fma_f32 v36, v36, s80, -v52
    v_fma_f32 v37, v37, s80, -v52
    v_fma_f32 v38, v38, s80, -v52
    v_fma_f32 v39, v39, s80, -v52
    v_fma_f32 v40, v40, s80, -v52
    v_fma_f32 v41, v41, s80, -v52
    v_fma_f32 v42, v42, s80, -v52
    v_fma_f32 v43, v43, s80, -v52
    v_fma_f32 v44, v44, s80, -v52
    v_fma_f32 v45, v45, s80, -v52
    v_fma_f32 v46, v46, s80, -v52
    v_fma_f32 v47, v47, s80, -v52
    v_fma_f32 v48, v48, s80, -v52
    v_fma_f32 v49, v49, s80, -v52
    v_fma_f32 v50, v50, s80, -v52
    v_fma_f32 v51, v51, s80, -v52
    s_cbranch_vccnz L_t_62
    s_waitcnt vmcnt(5)
L_t_62:
    buffer_load_dwordx4 a[192:195], v2, s[12:15], s68 offen nt
    s_addk_i32 s68, 1024
    s_and_b32 s68, s68, s69
    v_exp_f32 v20, v20
    v_exp_f32 v21, v21
    v_exp_f32 v22, v22
    v_add_f32 v53, v20, v21
    v_exp_f32 v23, v23
    v_add_f32 v53, v53, v22
    v_exp_f32 v24, v24
    v_add_f32 v53, v53, v23
    v_exp_f32 v25, v25
    v_add_f32 v53, v53, v24
    v_exp_f32 v26, v26
    v_add_f32 v53, v53, v25
    v_exp_f32 v27, v27
    v_add_f32 v53, v53, v26
    v_exp_f32 v28, v28
    v_add_f32 v53, v53, v27
    v_exp_f32 v29, v29
    v_add_f32 v53, v53, v28
    v_exp_f32 v30, v30
    v_add_f32 v53, v53, v29
    v_exp_f32 v31, v31
    v_add_f32 v53, v53, v30
    v_exp_f32 v32, v32
    v_add_f32 v53, v53, v31
    v_exp_f32 v33, v33
    v_add_f32 v53, v53, v32
    v_exp_f32 v34, v34
    v_add_f32 v53, v53, v33
    v_exp_f32 v35, v35
    v_add_f32 v53, v53, v34
    s_cbranch_vccnz L_t_63
    s_waitcnt vmcnt(5)
L_t_63:
    buffer_load_dwordx4 a[196:199], v2, s[12:15], s68 offen nt
    s_addk_i32 s68, 1024
    s_and_b32 s68, s68, s69
    v_exp_f32 v36, v36
    v_add_f32 v53, v53, v35
    v_exp_f32 v37, v37
    v_add_f32 v53, v53, v36
    v_exp_f32 v38, v38
    v_add_f32 v53, v53, v37
    v_exp_f32 v39, v39
    v_add_f32 v53, v53, v38
    v_exp_f32 v40, v40
    v_add_f32 v53, v53, v39
    v_exp_f32 v41, v41
    v_add_f32 v53, v53, v40
    v_exp_f32 v42, v42
    v_add_f32 v53, v53, v41
    v_exp_f32 v43, v43
    v_add_f32 v53, v53, v42
    v_exp_f32 v44, v44
    v_add_f32 v53, v53, v43
    v_exp_f32 v45, v45
    v_add_f32 v53, v53, v44
    v_exp_f32 v46, v46
    v_add_f32 v53, v53, v45
    v_exp_f32 v47, v47
    v_add_f32 v53, v53, v46
    v_exp_f32 v48, v48
    v_add_f32 v53, v53, v47
    v_exp_f32 v49, v49
    v_add_f32 v53, v53, v48
    v_exp_f32 v50, v50
    v_add_f32 v53, v53, v49
    v_exp_f32 v51, v51
    v_add_f32 v53, v53, v50
    v_add_f32 v53, v53, v51
    s_cbranch_vccnz L_t_64
    s_waitcnt vmcnt(5)
L_t_64:
    buffer_load_dwordx4 a[200:203], v2, s[12:15], s68 offen nt
    s_addk_i32 s68, 1024
    s_and_b32 s68, s68, s69
    v_mov_b32 v97, v53
    s_nop 1
    v_permlane16_swap_b32 v53, v97
    v_add_f32 v53, v53, v97
    v_mov_b32 v97, v53
    s_nop 1
    v_permlane32_swap_b32 v53, v97
    v_add_f32 v53, v53, v97
    v_bfe_u32 v97, v0, 2, 1
    v_lshlrev_b32 v97, 5, v97
    s_lshl_b32 s82, s3, 3
    s_add_u32 s82, s82, 156672
    v_add_u32 v97, s82, v97
    s_mov_b64 exec, 0x11
    ds_write_b64 v97, v[52:53]
    s_mov_b64 exec, -1
    s_waitcnt vmcnt(9)
    v_cvt_pk_bf16_f32 v99, v20, v20
    v_and_b32 v84, v99, v12
    v_and_b32 v85, v99, v13
    v_and_b32 v86, v99, v14
    v_and_b32 v87, v99, v15
    v_cvt_pk_bf16_f32 v99, v21, v21
    v_and_b32 v88, v99, v12
    v_and_b32 v89, v99, v13
    v_and_b32 v90, v99, v14
    v_and_b32 v91, v99, v15
    v_mfma_f32_16x16x32_bf16 v[16:19], v[84:87], a[128:131], 0
    v_cvt_pk_bf16_f32 v99, v22, v22
    v_and_b32 v84, v99, v12
    v_and_b32 v85, v99, v13
    v_and_b32 v86, v99, v14
    v_and_b32 v87, v99, v15
    v_mfma_f32_16x16x32_bf16 v[16:19], v[88:91], a[132:135], v[16:19]
    v_cvt_pk_bf16_f32 v99, v23, v23
    v_and_b32 v88, v99, v12
    v_and_b32 v89, v99, v13
    v_and_b32 v90, v99, v14
    v_and_b32 v91, v99, v15
    v_mfma_f32_16x16x32_bf16 v[16:19], v[84:87], a[136:139], v[16:19]
    v_cvt_pk_bf16_f32 v99, v24, v24
    v_and_b32 v84, v99, v12
    v_and_b32 v85, v99, v13
    v_and_b32 v86, v99, v14
    v_and_b32 v87, v99, v15
    v_mfma_f32_16x16x32_bf16 v[16:19], v[88:91], a[140:143], v[16:19]
    v_cvt_pk_bf16_f32 v99, v25, v25
    v_and_b32 v88, v99, v12
    v_and_b32 v89, v99, v13
    v_and_b32 v90, v99, v14
    v_and_b32 v91, v99, v15
    v_mfma_f32_16x16x32_bf16 v[16:19], v[84:87], a[144:147], v[16:19]
    s_cbranch_vccnz L_t_65
    s_waitcnt vmcnt(5)
L_t_65:
    buffer_load_dwordx4 a[204:207], v2, s[12:15], s68 offen nt
    s_addk_i32 s68, 1024
    s_and_b32 s68, s68, s69
    v_cvt_pk_bf16_f32 v99, v26, v26
    v_and_b32 v84, v99, v12
    v_and_b32 v85, v99, v13
    v_and_b32 v86, v99, v14
    v_and_b32_e64 v87, v99, v15
    v_mfma_f32_16x16x32_bf16 v[16:19], v[88:91], a[148:151], v[16:19]
    v_cvt_pk_bf16_f32 v99, v27, v27
    v_and_b32 v88, v99, v12
    v_and_b32 v89, v99, v13
    v_and_b32 v90, v99, v14
    v_and_b32 v91, v99, v15
    v_mfma_f32_16x16x32_bf16 v[16:19], v[84:87], a[152:155], v[16:19]
    v_cvt_pk_bf16_f32 v99, v28, v28
    v_and_b32 v84, v99, v12
    v_and_b32 v85, v99, v13
    v_and_b32 v86, v99, v14
    v_and_b32 v87, v99, v15
    v_mfma_f32_16x16x32_bf16 v[16:19], v[88:91], a[156:159], v[16:19]
    v_cvt_pk_bf16_f32 v99, v29, v29
    v_and_b32 v88, v99, v12
    v_and_b32 v89, v99, v13
    v_and_b32 v90, v99, v14
    v_and_b32 v91, v99, v15
    v_mfma_f32_16x16x32_bf16 v[16:19], v[84:87], a[160:163], v[16:19]
    v_cvt_pk_bf16_f32 v99, v30, v30
    v_and_b32 v84, v99, v12
    v_and_b32 v85, v99, v13
    v_and_b32 v86, v99, v14
    v_and_b32 v87, v99, v15
    v_mfma_f32_16x16x32_bf16 v[16:19], v[88:91], a[164:167], v[16:19]
    s_cbranch_vccnz L_t_66
    s_waitcnt vmcnt(5)
L_t_66:
    buffer_load_dwordx4 a[208:211], v2, s[12:15], s68 offen nt
    s_addk_i32 s68, 1024
    s_and_b32 s68, s68, s69
    s_waitcnt lgkmcnt(0)
    s_barrier
    v_and_b32 v97, 1, v93
    v_lshlrev_b32 v97, 5, v97
    v_add_u32_e64 v98, s82, v97
    v_add_u32 v97, 156672, v97
    ds_read_b128 v[56:59], v97
    ds_read_b128 v[60:63], v97 offset:16
    ds_read_b32 v64, v98
    s_cbranch_vccnz L_t_67
    s_waitcnt vmcnt(5)
L_t_67:
    buffer_load_dwordx4 a[212:215], v2, s[12:15], s68 offen nt
    s_addk_i32 s68, 1024
    s_and_b32 s68, s68, s69
    s_waitcnt lgkmcnt(0)
    v_max3_f32 v65, v56, v58, v60
    v_max_f32 v65, v65, v62
    v_sub_f32 v56, v56, v65
    v_sub_f32 v58, v58, v65
    v_sub_f32 v60, v60, v65
    v_sub_f32 v62, v62, v65
    v_sub_f32 v64, v64, v65
    v_exp_f32 v56, v56
    v_exp_f32 v58, v58
    v_exp_f32 v60, v60
    v_exp_f32 v62, v62
    v_exp_f32 v64, v64
    v_mul_f32 v66, v56, v57
    v_fmac_f32 v66, v58, v59
    v_fmac_f32 v66, v60, v61
    v_fmac_f32 v66, v62, v63
    v_rcp_f32 v67, v66
    v_log_f32 v66, v66
    v_mul_f32 v7, v64, v67
    v_add_f32_e64 v66, v66, v65
    s_cmp_eq_u32 s3, 0
    s_cbranch_scc0 L_nolse
    s_lshl_b32 s82, s4, 5
    s_add_u32 s82, s82, s5
    s_lshl_b32 s82, s82, 7
    s_add_u32 s82, s82, 417792
    v_and_b32 v65, 15, v0
    v_lshlrev_b32 v65, 4, v65
    v_lshl_add_u32 v65, v93, 3, v65
    v_mov_b32_e64 v67, s54
    s_mov_b64 exec, 0x00ff00ff
    s_cmp_eq_u32 s55, 1
    s_cbranch_scc0 L_far_68
    buffer_store_dwordx2 v[66:67], v65, s[20:23], s82 offen
    s_branch L_st_69
L_far_68:
    buffer_store_dwordx2 v[66:67], v65, s[20:23], s82 offen sc1
L_st_69:
    s_mov_b64 exec, -1
L_nolse:
    s_waitcnt vmcnt(9)
    v_mfma_f32_16x16x32_bf16 v[16:19], v[84:87], a[168:171], v[16:19]
    v_cvt_pk_bf16_f32 v99, v31, v31
    v_and_b32 v88, v99, v12
    v_and_b32 v89, v99, v13
    v_and_b32 v90, v99, v14
    v_and_b32 v91, v99, v15
    s_nop 1
    v_mfma_f32_16x16x32_bf16 v[16:19], v[88:91], a[172:175], v[16:19]
    v_cvt_pk_bf16_f32 v99, v32, v32
    v_and_b32 v84, v99, v12
    v_and_b32 v85, v99, v13
    v_and_b32 v86, v99, v14
    v_and_b32 v87, v99, v15
    s_nop 1
    v_mfma_f32_16x16x32_bf16 v[16:19], v[84:87], a[176:179], v[16:19]
    s_lshl_b32 s82, s76, 13
    s_lshl_b32 s83, s77, 8
    s_add_u32 s82, s82, s83
    s_add_u32 s57, s82, 450560
    v_and_b32 v97, 15, v0
    v_lshlrev_b32 v97, 4, v97
    v_and_b32_e64 v98, 1, v93
    v_lshl_add_u32 v97, v98, 12, v97
    v_lshrrev_b32 v98, 1, v93
    v_lshl_add_u32 v97, v98, 3, v97
    s_lshl_b32 s82, s3, 10
    s_add_u32 s82, s82, 152576
    v_add_u32_e64 v98, s82, v2
    s_cbranch_vccnz L_t_70
    s_waitcnt vmcnt(5)
L_t_70:
    buffer_load_dwordx4 a[216:219], v2, s[12:15], s68 offen nt
    s_addk_i32 s68, 1024
    s_and_b32 s68, s68, s69
    v_cvt_pk_bf16_f32 v99, v43, v43
    v_and_b32 v244, v99, v12
    v_and_b32 v245, v99, v13
    v_and_b32 v246, v99, v14
    v_and_b32 v247, v99, v15
    v_cvt_pk_bf16_f32 v99, v33, v33
    v_and_b32 v88, v99, v12
    v_and_b32 v89, v99, v13
    v_and_b32 v90, v99, v14
    v_and_b32 v91, v99, v15
    s_waitcnt vmcnt(9)
    s_nop 0
    v_mfma_f32_16x16x32_bf16 v[16:19], v[88:91], a[180:183], v[16:19]
    s_cbranch_vccnz L_t_71
    s_waitcnt vmcnt(5)
L_t_71:
    buffer_load_dwordx4 a[220:223], v2, s[12:15], s68 offen nt
    s_addk_i32 s68, 1024
    s_and_b32 s68, s68, s69
    v_cvt_pk_bf16_f32 v99, v44, v44
    v_and_b32 v240, v99, v12
    v_and_b32 v241, v99, v13
    v_and_b32 v242, v99, v14
    v_and_b32 v243, v99, v15
    v_cvt_pk_bf16_f32 v99, v34, v34
    v_and_b32 v84, v99, v12
    v_and_b32 v85, v99, v13
    v_and_b32 v86, v99, v14
    v_and_b32 v87, v99, v15
    s_waitcnt vmcnt(9)
    s_nop 0
    v_mfma_f32_16x16x32_bf16 v[16:19], v[84:87], a[184:187], v[16:19]
    s_cbranch_vccnz L_t_72
    s_waitcnt vmcnt(5)
L_t_72:
    buffer_load_dwordx4 a[224:227], v2, s[12:15], s68 offen nt
    s_addk_i32 s68, 1024
    s_and_b32 s68, s68, s69
    v_cvt_pk_bf16_f32 v99, v45, v45
    v_and_b32 v236, v99, v12
    v_and_b32 v237, v99, v13
    v_and_b32 v238, v99, v14
    v_and_b32 v239, v99, v15
    v_cvt_pk_bf16_f32 v99, v35, v35
    v_and_b32 v88, v99, v12
    v_and_b32 v89, v99, v13
    v_and_b32 v90, v99, v14
    v_and_b32 v91, v99, v15
    s_waitcnt vmcnt(9)
    s_nop 0
    v_mfma_f32_16x16x32_bf16 v[16:19], v[88:91], a[188:191], v[16:19]
    s_cbranch_vccnz L_t_73
    s_waitcnt vmcnt(5)
L_t_73:
    buffer_load_dwordx4 a[228:231], v2, s[12:15], s68 offen nt
    s_addk_i32 s68, 1024
    s_and_b32 s68, s68, s69
    v_cvt_pk_bf16_f32 v99, v46, v46
    v_and_b32 v232, v99, v12
    v_and_b32 v233, v99, v13
    v_and_b32 v234, v99, v14
    v_and_b32 v235, v99, v15
    v_cvt_pk_bf16_f32 v99, v36, v36
    v_and_b32 v84, v99, v12
    v_and_b32 v85, v99, v13
    v_and_b32 v86, v99, v14
    v_and_b32 v87, v99, v15
    s_waitcnt vmcnt(9)
    s_nop 0
    v_mfma_f32_16x16x32_bf16 v[16:19], v[84:87], a[192:195], v[16:19]
    s_cbranch_vccnz L_t_74
    s_waitcnt vmcnt(5)
L_t_74:
    buffer_load_dwordx4 a[232:235], v2, s[12:15], s68 offen nt
    s_addk_i32 s68, 1024
    s_and_b32 s68, s68, s69
    v_cvt_pk_bf16_f32 v99, v47, v47
    v_and_b32 v228, v99, v12
    v_and_b32 v229, v99, v13
    v_and_b32 v230, v99, v14
    v_and_b32 v231, v99, v15
    v_cvt_pk_bf16_f32 v99, v37, v37
    v_and_b32 v88, v99, v12
    v_and_b32 v89, v99, v13
    v_and_b32 v90, v99, v14
    v_and_b32 v91, v99, v15
    s_waitcnt vmcnt(9)
    s_nop 0
    v_mfma_f32_16x16x32_bf16 v[16:19], v[88:91], a[196:199], v[16:19]
    s_cbranch_vccnz L_t_75
    s_waitcnt vmcnt(5)
L_t_75:
    buffer_load_dwordx4 a[236:239], v2, s[12:15], s68 offen nt
    s_addk_i32 s68, 1024
    s_and_b32 s68, s68, s69
    v_cvt_pk_bf16_f32 v99, v48, v48
    v_and_b32 v224, v99, v12
    v_and_b32 v225, v99, v13
    v_and_b32 v226, v99, v14
    v_and_b32 v227, v99, v15
    v_cvt_pk_bf16_f32 v99, v38, v38
    v_and_b32 v84, v99, v12
    v_and_b32 v85, v99, v13
    v_and_b32 v86, v99, v14
    v_and_b32 v87, v99, v15
    s_waitcnt vmcnt(9)
    s_nop 0
    v_mfma_f32_16x16x32_bf16 v[16:19], v[84:87], a[200:203], v[16:19]
    s_cbranch_vccnz L_t_76
    s_waitcnt vmcnt(5)
L_t_76:
    buffer_load_dwordx4 a[240:243], v2, s[12:15], s68 offen nt
    s_addk_i32 s68, 1024
    s_and_b32 s68, s68, s69
    v_cvt_pk_bf16_f32 v99, v49, v49
    v_and_b32 v220, v99, v12
    v_and_b32 v221, v99, v13
    v_and_b32 v222, v99, v14
    v_and_b32 v223, v99, v15
    v_cvt_pk_bf16_f32 v99, v39, v39
    v_and_b32 v88, v99, v12
    v_and_b32 v89, v99, v13
    v_and_b32 v90, v99, v14
    v_and_b32 v91, v99, v15
    s_waitcnt vmcnt(9)
    s_nop 0
    v_mfma_f32_16x16x32_bf16 v[16:19], v[88:91], a[204:207], v[16:19]
    s_cbranch_vccnz L_t_77
    s_waitcnt vmcnt(5)
L_t_77:
    buffer_load_dwordx4 a[244:247], v2, s[12:15], s68 offen nt
    s_addk_i32 s68, 1024
    s_and_b32 s68, s68, s69
    v_cvt_pk_bf16_f32 v99, v50, v50
    v_and_b32 v216, v99, v12
    v_and_b32 v217, v99, v13
    v_and_b32 v218, v99, v14
    v_and_b32 v219, v99, v15
    v_cvt_pk_bf16_f32 v99, v40, v40
    v_and_b32 v84, v99, v12
    v_and_b32 v85, v99, v13
    v_and_b32 v86, v99, v14
    v_and_b32 v87, v99, v15
    s_waitcnt vmcnt(9)
    s_nop 0
    v_mfma_f32_16x16x32_bf16 v[16:19], v[84:87], a[208:211], v[16:19]
    s_cbranch_vccnz L_t_78
    s_waitcnt vmcnt(5)
L_t_78:
    buffer_load_dwordx4 a[248:251], v2, s[12:15], s68 offen nt
    s_addk_i32 s68, 1024
    s_and_b32 s68, s68, s69
    v_cvt_pk_bf16_f32 v99, v51, v51
    v_and_b32 v212, v99, v12
    v_and_b32 v213, v99, v13
    v_and_b32 v214, v99, v14
    v_and_b32 v215, v99, v15
    v_cvt_pk_bf16_f32 v99, v41, v41
    v_and_b32 v88, v99, v12
    v_and_b32 v89, v99, v13
    v_and_b32 v90, v99, v14
    v_and_b32 v91, v99, v15
    s_waitcnt vmcnt(9)
    s_nop 0
    v_mfma_f32_16x16x32_bf16 v[16:19], v[88:91], a[212:215], v[16:19]
    s_cbranch_vccnz L_t_79
    s_waitcnt vmcnt(5)
L_t_79:
    buffer_load_dwordx4 a[252:255], v2, s[12:15], s68 offen nt
    s_addk_i32 s68, 1024
    s_and_b32 s68, s68, s69
    v_cvt_pk_bf16_f32 v99, v42, v42
    v_and_b32 v84, v99, v12
    v_and_b32 v85, v99, v13
    v_and_b32 v86, v99, v14
    v_and_b32 v87, v99, v15
    s_waitcnt vmcnt(9)
    s_nop 0
    v_mfma_f32_16x16x32_bf16 v[16:19], v[84:87], a[216:219], v[16:19]
    s_branch L_tails
.p2align 12
L_tails:
    s_bitcmp1_b32 s6, 0
    s_cbranch_scc0 L_ft
    s_cmp_eq_u32 s6, 1
    s_cbranch_scc0 L_nw
    s_mov_b64 exec, 0xffff
    buffer_load_dwordx2 v[180:181], v177, s[20:23], s64 offen sc1
    s_mov_b64 exec, -1
L_x1:
    s_waitcnt vmcnt(9)
    v_mfma_f32_16x16x32_bf16 v[16:19], v[244:247], a[220:223], v[16:19]
    s_waitcnt vmcnt(8)
    v_mfma_f32_16x16x32_bf16 v[16:19], v[240:243], a[224:227], v[16:19]
    s_waitcnt vmcnt(7)
    v_mfma_f32_16x16x32_bf16 v[16:19], v[236:239], a[228:231], v[16:19]
    s_waitcnt vmcnt(6)
    v_mfma_f32_16x16x32_bf16 v[16:19], v[232:235], a[232:235], v[16:19]
    s_waitcnt vmcnt(5)
    v_mfma_f32_16x16x32_bf16 v[16:19], v[228:231], a[236:239], v[16:19]
    s_waitcnt vmcnt(4)
    v_mfma_f32_16x16x32_bf16 v[16:19], v[224:227], a[240:243], v[16:19]
    s_waitcnt vmcnt(3)
    v_mfma_f32_16x16x32_bf16 v[16:19], v[220:223], a[244:247], v[16:19]
    s_waitcnt vmcnt(2)
    v_mfma_f32_16x16x32_bf16 v[16:19], v[216:219], a[248:251], v[16:19]
    s_waitcnt vmcnt(1)
    v_mfma_f32_16x16x32_bf16 v[16:19], v[212:215], a[252:255], v[16:19]
    s_nop 6
    s_branch L_comb
L_nw:
    s_waitcnt vmcnt(8)
    v_mfma_f32_16x16x32_bf16 v[16:19], v[244:247], a[220:223], v[16:19]
    s_waitcnt vmcnt(7)
    v_mfma_f32_16x16x32_bf16 v[16:19], v[240:243], a[224:227], v[16:19]
    s_waitcnt vmcnt(6)
    v_mfma_f32_16x16x32_bf16 v[16:19], v[236:239], a[228:231], v[16:19]
    s_waitcnt vmcnt(5)
    v_mfma_f32_16x16x32_bf16 v[16:19], v[232:235], a[232:235], v[16:19]
    s_waitcnt vmcnt(4)
    v_mfma_f32_16x16x32_bf16 v[16:19], v[228:231], a[236:239], v[16:19]
    s_waitcnt vmcnt(3)
    v_mfma_f32_16x16x32_bf16 v[16:19], v[224:227], a[240:243], v[16:19]
    s_waitcnt vmcnt(2)
    v_mfma_f32_16x16x32_bf16 v[16:19], v[220:223], a[244:247], v[16:19]
    s_waitcnt vmcnt(1)
    v_mfma_f32_16x16x32_bf16 v[16:19], v[216:219], a[248:251], v[16:19]
    s_waitcnt vmcnt(0)
    v_mfma_f32_16x16x32_bf16 v[16:19], v[212:215], a[252:255], v[16:19]
    s_nop 6
    s_branch L_comb
L_ft:
    buffer_load_dwordx4 v6, s[28:31], s73 offen nt lds
    s_addk_i32 m0, 0x1000
    s_add_u32 s73, s73, 294912
    s_waitcnt vmcnt(9)
    v_mfma_f32_16x16x32_bf16 v[16:19], v[244:247], a[220:223], v[16:19]
    buffer_load_dwordx4 v6, s[28:31], s73 offen nt lds
    s_addk_i32 m0, 0x1000
    s_add_u32 s73, s73, 294912
    s_waitcnt vmcnt(9)
    v_mfma_f32_16x16x32_bf16 v[16:19], v[240:243], a[224:227], v[16:19]
    buffer_load_dwordx4 v6, s[28:31], s73 offen nt lds
    s_addk_i32 m0, 0x1000
    s_add_u32 s73, s73, 294912
    s_waitcnt vmcnt(9)
    v_mfma_f32_16x16x32_bf16 v[16:19], v[236:239], a[228:231], v[16:19]
    buffer_load_dwordx4 v6, s[28:31], s73 offen nt lds
    s_addk_i32 m0, 0x1000
    s_add_u32 s73, s73, 294912
    s_waitcnt vmcnt(9)
    v_mfma_f32_16x16x32_bf16 v[16:19], v[232:235], a[232:235], v[16:19]
    buffer_load_dwordx4 v6, s[28:31], s73 offen nt lds
    s_addk_i32 m0, 0x1000
    s_add_u32 s73, s73, 294912
    s_waitcnt vmcnt(9)
    v_mfma_f32_16x16x32_bf16 v[16:19], v[228:231], a[236:239], v[16:19]
    s_waitcnt vmcnt(8)
    v_mfma_f32_16x16x32_bf16 v[16:19], v[224:227], a[240:243], v[16:19]
    s_waitcnt vmcnt(7)
    v_mfma_f32_16x16x32_bf16 v[16:19], v[220:223], a[244:247], v[16:19]
    s_waitcnt vmcnt(6)
    v_mfma_f32_16x16x32_bf16 v[16:19], v[216:219], a[248:251], v[16:19]
    s_waitcnt vmcnt(5)
    v_mfma_f32_16x16x32_bf16 v[16:19], v[212:215], a[252:255], v[16:19]
    s_nop 7
L_comb:
    v_mul_f32 v16, v16, v7
    v_mul_f32 v17, v17, v7
    v_mul_f32 v18, v18, v7
    v_mul_f32 v19, v19, v7
    ds_write_b128 v98, v[16:19]
    s_cmp_eq_u32 s3, 0
    s_waitcnt lgkmcnt(0)
    s_barrier
    s_cbranch_scc0 L_pubd
    ds_read_b128 v[56:59], v98 offset:1024
    ds_read_b128 v[60:63], v98 offset:2048
    ds_read_b128 v[64:67], v98 offset:3072
    s_waitcnt lgkmcnt(2)
    v_pk_add_f32 v[16:17], v[16:17], v[56:57]
    v_pk_add_f32 v[18:19], v[18:19], v[58:59]
    s_waitcnt lgkmcnt(1)
    v_pk_add_f32 v[16:17], v[16:17], v[60:61]
    v_pk_add_f32 v[18:19], v[18:19], v[62:63]
    s_waitcnt lgkmcnt(0)
    v_pk_add_f32 v[16:17], v[16:17], v[64:65]
    v_pk_add_f32 v[18:19], v[18:19], v[66:67]
    v_cvt_pk_bf16_f32 v16, v16, v17
    v_cvt_pk_bf16_f32 v17, v18, v19
    v_min_u32 v16, -2, v16
    v_min_u32 v17, -2, v17
    s_cmp_eq_u32 s55, 1
    s_cbranch_scc0 L_far_80
    buffer_store_dwordx2 v[16:17], v97, s[20:23], s57 offen
    s_branch L_st_81
L_far_80:
    buffer_store_dwordx2 v[16:17], v97, s[20:23], s57 offen sc1
L_st_81:
L_pubd:
    s_mov_b32 s81, 0
    s_bitcmp1_b32 s6, 0
    s_cbranch_scc0 L_F
    s_cmp_eq_u32 s6, 1
    s_cbranch_scc0 L_R
    buffer_load_dwordx4 v[20:23], v2, s[20:23], s63 offen offset:0 sc1
    buffer_load_dwordx4 v[24:27], v2, s[20:23], s63 offen offset:1024 sc1
    buffer_load_dwordx4 v[28:31], v2, s[20:23], s63 offen offset:2048 sc1
    buffer_load_dwordx4 v[32:35], v2, s[20:23], s63 offen offset:3072 sc1
    s_waitcnt vmcnt(5)
    s_cmp_eq_u32 s3, 0
    s_cbranch_scc1 L_tab1
    s_waitcnt vmcnt(4)
    s_branch L_tab1
L_tab:
    s_mov_b64 exec, 0xffff
    buffer_load_dwordx2 v[180:181], v177, s[20:23], s64 offen sc1
    s_mov_b64 exec, -1
    s_waitcnt vmcnt(0)
L_tab1:
    v_cmp_ne_u32 vcc, s54, v181
    s_cbranch_vccnz L_again_83
L_ok_82:
    v_max_f32_dpp v181, v180, v180 quad_perm:[1,0,3,2] row_mask:0xf bank_mask:0xf
    s_nop 1
    v_max_f32_dpp v181, v181, v181 quad_perm:[2,3,0,1] row_mask:0xf bank_mask:0xf
    v_sub_f32 v180, v180, v181
    v_exp_f32 v180, v180
    s_nop 1
    v_add_f32_dpp v181, v180, v180 quad_perm:[1,0,3,2] row_mask:0xf bank_mask:0xf
    s_nop 1
    v_add_f32_dpp v181, v181, v181 quad_perm:[2,3,0,1] row_mask:0xf bank_mask:0xf
    v_rcp_f32 v181, v181
    s_nop 0
    v_mul_f32 v180, v180, v181
    s_mov_b64 exec, 0xffff
    ds_write_b32 v179, v180
    s_mov_b64 exec, -1
    v_mov_b32 v8, s54
    v_mov_b32 v9, s54
    v_mov_b32 v10, s54
    v_mov_b32 v11, s54
    v_mov_b32 v12, v205
    s_add_u32 s82, s3, s7
    s_branch L_wchk
L_wa:
    s_mov_b64 exec, vcc
    buffer_load_dwordx4 v[20:23], v2, s[20:23], s63 offen offset:0 sc1
    buffer_load_dwordx4 v[24:27], v2, s[20:23], s63 offen offset:1024 sc1
    buffer_load_dwordx4 v[28:31], v2, s[20:23], s63 offen offset:2048 sc1
    buffer_load_dwordx4 v[32:35], v2, s[20:23], s63 offen offset:3072 sc1
    s_mov_b64 exec, -1
L_wchk:
    s_waitcnt vmcnt(3)
    ds_write_b128 v172, v[20:23] offset:0
    v_max3_u32 v99, v20, v21, v22
    v_max_u32_e64 v99, v23, v99
    s_waitcnt vmcnt(2)
    ds_write_b128 v173, v[24:27] offset:0
    v_max3_u32 v99, v24, v25, v99
    v_max3_u32 v99, v26, v27, v99
    s_waitcnt vmcnt(1)
    ds_write_b128 v172, v[28:31] offset:128
    v_max3_u32 v99, v28, v29, v99
    v_max3_u32 v99, v30, v31, v99
    s_waitcnt vmcnt(0)
    ds_write_b128 v173, v[32:35] offset:128
    v_max3_u32 v99, v32, v33, v99
    v_max3_u32 v99, v34, v35, v99
    s_waitcnt lgkmcnt(0)
    v_cmp_eq_u32 vcc, -1, v99
    s_cbranch_vccnz L_again_85
L_ok_84:
    s_cmp_eq_u32 s82, 0
    s_barrier
    s_cbranch_scc0 L_wns
    buffer_store_dwordx4 v[8:11], v12, s[20:23], s61 offen sc1
L_wns:
    ds_read_b128 v[188:191], v174 offset:0
    ds_read_b128 v[192:195], v175 offset:1024
    ds_read_b128 v[196:199], v174 offset:2048
    ds_read_b128 v[200:203], v175 offset:3072
    ds_read_b128 v[204:207], v174 offset:4096
    s_waitcnt lgkmcnt(4)
    v_mfma_f32_16x16x32_bf16 v[36:39], v[100:103], v[188:191], 0
    ds_read_b128 v[208:211], v175 offset:5120
    s_waitcnt lgkmcnt(4)
    v_mfma_f32_16x16x32_bf16 v[36:39], v[104:107], v[192:195], v[36:39]
    ds_read_b128 v[212:215], v174 offset:6144
    s_waitcnt lgkmcnt(4)
    v_mfma_f32_16x16x32_bf16 v[36:39], v[108:111], v[196:199], v[36:39]
    ds_read_b128 v[216:219], v175 offset:7168
    ds_read_b128 v[20:23], v178
    s_waitcnt lgkmcnt(5)
    v_mfma_f32_16x16x32_bf16 v[36:39], v[112:115], v[200:203], v[36:39]
    ds_read_b128 v[220:223], v174 offset:8192
    s_waitcnt lgkmcnt(5)
    v_mfma_f32_16x16x32_bf16 v[40:43], v[116:119], v[204:207], 0
    ds_read_b128 v[224:227], v175 offset:9216
    s_waitcnt lgkmcnt(5)
    v_mfma_f32_16x16x32_bf16 v[40:43], v[120:123], v[208:211], v[40:43]
    ds_read_b128 v[228:231], v174 offset:10240
    s_waitcnt lgkmcnt(5)
    v_mfma_f32_16x16x32_bf16 v[40:43], v[124:127], v[212:215], v[40:43]
    ds_read_b128 v[232:235], v175 offset:11264
    s_waitcnt lgkmcnt(5)
    v_mfma_f32_16x16x32_bf16 v[40:43], v[128:131], v[216:219], v[40:43]
    ds_read_b128 v[236:239], v174 offset:12288
    s_waitcnt lgkmcnt(4)
    v_mfma_f32_16x16x32_bf16 v[44:47], v[132:135], v[220:223], 0
    ds_read_b128 v[240:243], v175 offset:13312
    v_mul_f32 v52, v36, v20
    s_waitcnt lgkmcnt(4)
    v_mfma_f32_16x16x32_bf16 v[44:47], v[136:139], v[224:227], v[44:47]
    ds_read_b128 v[244:247], v174 offset:14336
    v_mul_f32 v53, v37, v20
    s_waitcnt lgkmcnt(4)
    v_mfma_f32_16x16x32_bf16 v[44:47], v[140:143], v[228:231], v[44:47]
    ds_read_b128 v[248:251], v175 offset:15360
    v_mul_f32_e64 v54, v38, v20
    s_waitcnt lgkmcnt(4)
    v_mfma_f32_16x16x32_bf16 v[44:47], v[144:147], v[232:235], v[44:47]
    v_mul_f32 v55, v39, v20
    s_waitcnt lgkmcnt(3)
    v_mfma_f32_16x16x32_bf16 v[48:51], v[148:151], v[236:239], 0
    v_fmac_f32 v52, v40, v21
    s_waitcnt lgkmcnt(2)
    v_mfma_f32_16x16x32_bf16 v[48:51], v[152:155], v[240:243], v[48:51]
    v_fmac_f32 v53, v41, v21
    s_waitcnt lgkmcnt(1)
    v_mfma_f32_16x16x32_bf16 v[48:51], v[156:159], v[244:247], v[48:51]
    v_fmac_f32 v54, v42, v21
    s_waitcnt lgkmcnt(0)
    v_mfma_f32_16x16x32_bf16 v[48:51], v[160:163], v[248:251], v[48:51]
    v_fmac_f32 v55, v43, v21
    s_mov_b32 s82, 0x11111111
    s_mov_b32 s83, 0x11111111
    v_fmac_f32 v52, v44, v22
    v_fmac_f32 v53, v45, v22
    v_fmac_f32 v54, v46, v22
    v_fmac_f32 v55, v47, v22
    s_nop 0
    v_fmac_f32 v52, v48, v23
    v_fmac_f32 v53, v49, v23
    v_fmac_f32 v54, v50, v23
    v_fmac_f32 v55, v51, v23
    v_add_f32_dpp v52, v52, v52 quad_perm:[1,0,3,2] row_mask:0xf bank_mask:0xf
    v_add_f32_dpp v53, v53, v53 quad_perm:[1,0,3,2] row_mask:0xf bank_mask:0xf
    v_add_f32_dpp v54, v54, v54 quad_perm:[1,0,3,2] row_mask:0xf bank_mask:0xf
    v_add_f32_dpp v55, v55, v55 quad_perm:[1,0,3,2] row_mask:0xf bank_mask:0xf
    v_add_f32_dpp v52, v52, v52 quad_perm:[2,3,0,1] row_mask:0xf bank_mask:0xf
    v_add_f32_dpp v53, v53, v53 quad_perm:[2,3,0,1] row_mask:0xf bank_mask:0xf
    v_add_f32_dpp v54, v54, v54 quad_perm:[2,3,0,1] row_mask:0xf bank_mask:0xf
    v_add_f32_dpp v55, v55, v55 quad_perm:[2,3,0,1] row_mask:0xf bank_mask:0xf
    v_cvt_pk_bf16_f32 v52, v52, v53
    v_cvt_pk_bf16_f32 v53, v54, v55
    v_min_u32 v52, -2, v52
    v_min_u32 v53, -2, v53
    s_mov_b64 exec, s[82:83]
    buffer_store_dwordx2 v[52:53], v176, s[20:23], s62 offen sc1
    s_mov_b64 exec, -1
    s_mov_b32 s81, 0
    s_barrier
    s_mov_b32 exec_lo, 0xffffff
    s_mov_b32 exec_hi, 0x0
    buffer_load_dword v183, v182, s[24:27], s50 offen
    s_add_u32 s50, s50, 3072
    s_mov_b64 exec, -1
    s_branch L_R2
L_R:
    s_barrier
    s_mov_b32 exec_lo, 0xffffffff
    s_mov_b32 exec_hi, 0xffff
    buffer_load_dword v183, v182, s[24:27], s50 offen
    s_add_u32 s50, s50, 6144
    buffer_load_dword v183, v182, s[24:27], s50 offen
    s_add_u32 s50, s50, 6144
    buffer_load_dword v183, v182, s[24:27], s50 offen
    s_add_u32 s50, s50, 6144
    buffer_load_dword v183, v182, s[24:27], s50 offen
    s_add_u32 s50, s50, 6144
    buffer_load_dword v183, v182, s[24:27], s50 offen
    s_add_u32 s50, s50, 6144
    s_mov_b64 exec, -1
L_R2:
    s_cmp_eq_u32 s3, 0
    s_cbranch_scc0 L_fin
    v_and_b32 v97, 1, v0
    v_cmp_eq_u32 vcc, 1, v97
    v_mov_b32 v98, 0x3f80
    v_mov_b32 v99, 0x3f800000
    v_cndmask_b32 v98, v98, v99, vcc
    v_bfe_u32 v97, v0, 1, 3
    v_cmp_eq_u32 vcc, 0, v97
    s_nop 1
    v_cndmask_b32 v8, 0, v98, vcc
    v_cmp_eq_u32 vcc, 1, v97
    s_nop 1
    v_cndmask_b32 v9, 0, v98, vcc
    v_cmp_eq_u32 vcc, 2, v97
    s_nop 1
    v_cndmask_b32 v10, 0, v98, vcc
    v_mov_b32 v11, 0
    s_sub_u32 s59, s5, 18
    s_cmp_lt_u32 s59, 12
    s_cbranch_scc0 L_fin
    s_mul_i32 s57, s59, 43
    s_lshr_b32 s57, s57, 7
    s_mul_i32 s82, s57, 3
    s_sub_u32 s59, s59, s82
    s_and_b32 s82, s4, 1
    s_lshl_b32 s82, s82, 2
    s_add_u32 s57, s57, s82
    s_lshr_b32 s83, s4, 1
    s_mul_i32 s82, s83, 3
    s_add_u32 s82, s82, s59
    s_mul_i32 s44, s57, 12
    s_add_u32 s82, s82, s44
    s_lshr_b32 s44, s82, 1
    s_mul_i32 s44, s44, 18432
    s_and_b32 s82, s82, 1
    s_lshl_b32 s82, s82, 6
    s_add_u32 s44, s44, s82
    s_add_u32 s44, s44, 619520
    s_add_u32 s45, s44, 4096
    s_add_u32 s46, s44, 8192
    s_add_u32 s47, s44, 12288
    s_add_u32 s48, s44, 16384
    s_mul_i32 s58, s83, 1152
    s_lshr_b32 s82, s57, 1
    s_mul_i32 s82, s82, 9
    s_add_u32 s82, s82, s59
    s_lshl_b32 s82, s82, 5
    s_add_u32 s58, s58, s82
    s_and_b32 s57, s57, 1
    s_mul_i32 s82, s57, 192
    s_lshl_b32 s83, s57, 2
    s_add_u32 s83, s83, 96
    v_mov_b32 v28, s83
    v_mov_b32 v27, s82
    v_cmp_gt_u32 vcc, 16, v0
    s_nop 1
    v_cndmask_b32 v28, v28, v27, vcc
    v_lshl_add_u32 v28, v94, 3, v28
    v_lshrrev_b32 v31, 2, v0
    v_lshlrev_b32_e64 v31, 7, v31
    v_lshl_add_u32 v31, v94, 4, v31
    s_mov_b32 s75, 0xbfffbfff
    v_lshlrev_b32_e64 v29, 7, v0
    s_mul_i32 s61, s4, 1024
    s_add_u32 s61, s61, 1635328
    s_mov_b32 s60, 0
    s_mov_b64 exec, 0xff
    v_not_b32 v30, s54
L_rs:
    buffer_load_dword v30, v29, s[20:23], s61 offen sc1
    s_add_u32 s60, s60, 1
    s_cmp_gt_u32 s60, 2097152
    s_cbranch_scc1 L_rs1
    s_waitcnt vmcnt(1)
    v_cmp_ne_u32 vcc, s54, v30
    s_cbranch_vccnz L_rs
L_rs1:
    s_mov_b64 vcc, -1
L_ra:
    s_mov_b64 exec, vcc
    buffer_load_dwordx4 v[100:103], v31, s[20:23], s44 offen offset:0 sc1
    buffer_load_dwordx4 v[104:107], v31, s[20:23], s44 offen offset:2048 sc1
    buffer_load_dwordx4 v[108:111], v31, s[20:23], s45 offen offset:0 sc1
    buffer_load_dwordx4 v[112:115], v31, s[20:23], s45 offen offset:2048 sc1
    buffer_load_dwordx4 v[116:119], v31, s[20:23], s46 offen offset:0 sc1
    buffer_load_dwordx4 v[120:123], v31, s[20:23], s46 offen offset:2048 sc1
    buffer_load_dwordx4 v[124:127], v31, s[20:23], s47 offen offset:0 sc1
    buffer_load_dwordx4 v[128:131], v31, s[20:23], s47 offen offset:2048 sc1
    buffer_load_dwordx4 v[132:135], v31, s[20:23], s48 offen offset:0 sc1
    s_mov_b64 exec, -1
    s_waitcnt vmcnt(8)
    v_mfma_f32_16x16x32_bf16 v[52:55], v[8:11], v[100:103], 0
    v_bitop3_b32 v99, v100, v101, v102 bitop3:0x96
    v_bitop3_b32 v99, v99, v103, s0 bitop3:0x96
    s_waitcnt vmcnt(7)
    v_mfma_f32_16x16x32_bf16 v[52:55], v[8:11], v[104:107], v[52:55]
    v_bitop3_b32 v98, v104, v105, v106 bitop3:0x96
    v_bitop3_b32 v98, v98, v107, s0 bitop3:0x96
    s_waitcnt vmcnt(6)
    v_mfma_f32_16x16x32_bf16 v[52:55], v[8:11], v[108:111], v[52:55]
    v_bitop3_b32 v97, v108, v109, v110 bitop3:0x96
    v_bitop3_b32 v97, v97, v111, s0 bitop3:0x96
    v_or3_b32 v99, v99, v97, v98
    s_waitcnt vmcnt(5)
    v_mfma_f32_16x16x32_bf16 v[52:55], v[8:11], v[112:115], v[52:55]
    v_bitop3_b32 v98, v112, v113, v114 bitop3:0x96
    v_bitop3_b32 v98, v98, v115, s0 bitop3:0x96
    s_waitcnt vmcnt(4)
    v_mfma_f32_16x16x32_bf16 v[52:55], v[8:11], v[116:119], v[52:55]
    v_bitop3_b32 v97, v116, v117, v118 bitop3:0x96
    v_bitop3_b32 v97, v97, v119, s0 bitop3:0x96
    v_or3_b32 v99, v99, v97, v98
    s_waitcnt vmcnt(3)
    v_mfma_f32_16x16x32_bf16 v[52:55], v[8:11], v[120:123], v[52:55]
    v_bitop3_b32 v98, v120, v121, v122 bitop3:0x96
    v_bitop3_b32 v98, v98, v123, s0 bitop3:0x96
    s_waitcnt vmcnt(2)
    v_mfma_f32_16x16x32_bf16 v[52:55], v[8:11], v[124:127], v[52:55]
    v_bitop3_b32 v97, v124, v125, v126 bitop3:0x96
    v_bitop3_b32 v97, v97, v127, s0 bitop3:0x96
    v_or3_b32 v99, v99, v97, v98
    s_waitcnt vmcnt(1)
    v_mfma_f32_16x16x32_bf16 v[52:55], v[8:11], v[128:131], v[52:55]
    v_bitop3_b32 v98, v128, v129, v130 bitop3:0x96
    v_bitop3_b32 v98, v98, v131, s0 bitop3:0x96
    s_waitcnt vmcnt(0)
    v_mfma_f32_16x16x32_bf16 v[52:55], v[8:11], v[132:135], v[52:55]
    v_bitop3_b32 v97, v132, v133, v134 bitop3:0x96
    v_bitop3_b32 v97, v97, v135, s0 bitop3:0x96
    v_or3_b32 v99, v99, v97, v98
    v_and_b32 v99, s75, v99
    v_cmp_ne_u32_e64 vcc, 0, v99
    s_cbranch_vccnz L_again_87
L_ok_86:
    s_nop 1
    v_add_f32_dpp v52, v52, v52 row_ror:8 row_mask:0xf bank_mask:0xf
    v_add_f32_dpp v53, v53, v53 row_ror:8 row_mask:0xf bank_mask:0xf
    v_add_f32_dpp v54, v54, v54 row_ror:8 row_mask:0xf bank_mask:0xf
    v_add_f32_dpp v55, v55, v55 row_ror:8 row_mask:0xf bank_mask:0xf
    v_add_f32_dpp v52, v52, v52 row_ror:4 row_mask:0xf bank_mask:0xf
    v_add_f32_dpp v53, v53, v53 row_ror:4 row_mask:0xf bank_mask:0xf
    v_add_f32_dpp v54, v54, v54 row_ror:4 row_mask:0xf bank_mask:0xf
    v_add_f32_dpp v55, v55, v55 row_ror:4 row_mask:0xf bank_mask:0xf
    v_cvt_pk_bf16_f32 v52, v52, v53
    v_cvt_pk_bf16_f32 v53, v54, v55
    s_mov_b64 exec, 0x000f000f
    buffer_store_dword v52, v28, s[36:39], s58 offen
    s_mov_b64 exec, 15
    buffer_store_dword v53, v28, s[36:39], s58 offen offset:4
L_rend:
    s_endpgm
L_again_83:
    s_add_u32 s81, s81, 1
    s_cmp_lt_u32 s81, 2097152
    s_cbranch_scc1 L_tab
    s_branch L_ok_82
L_again_85:
    s_add_u32 s81, s81, 1
    s_cmp_lt_u32 s81, 2097152
    s_cbranch_scc1 L_wa
    s_branch L_ok_84
L_again_87:
    s_add_u32 s81, s81, 1
    s_cmp_lt_u32 s81, 2097152
    s_cbranch_scc1 L_ra
    s_branch L_ok_86
L_fin:
    s_endpgm
.p2align 12
L_F:
    s_barrier
    buffer_load_dwordx4 v6, s[28:31], s73 offen nt lds
    s_addk_i32 m0, 0x1000
    s_add_u32 s73, s73, 294912
    buffer_load_dwordx4 v6, s[28:31], s73 offen nt lds
    s_addk_i32 m0, 0x1000
    s_add_u32 s73, s73, 294912
    buffer_load_dwordx4 v6, s[28:31], s73 offen nt lds
    s_addk_i32 m0, 0x1000
    s_add_u32 s73, s73, 294912
    buffer_load_dwordx4 v6, s[28:31], s73 offen nt lds
    s_addk_i32 m0, 0x1000
    s_add_u32 s73, s73, 294912
    s_mov_b32 s73, s58
    buffer_load_dwordx4 v6, s[32:35], s73 offen nt lds
    s_addk_i32 m0, 0x1000
    s_add_u32 s73, s73, 294912
    buffer_load_dwordx4 v6, s[32:35], s73 offen nt lds
    s_addk_i32 m0, 0x1000
    s_add_u32 s73, s73, 294912
    buffer_load_dwordx4 v6, s[32:35], s73 offen nt lds
    s_addk_i32 m0, 0x1000
    s_add_u32 s73, s73, 294912
    buffer_load_dwordx4 v6, s[32:35], s73 offen nt lds
    s_addk_i32 m0, 0x1000
    s_add_u32 s73, s73, 294912
    buffer_load_dwordx4 v6, s[32:35], s73 offen nt lds
    s_addk_i32 m0, 0x1000
    s_add_u32 s73, s73, 294912
    buffer_load_dwordx4 v6, s[32:35], s73 offen nt lds
    s_addk_i32 m0, 0x1000
    s_add_u32 s73, s73, 294912
    buffer_load_dwordx4 v6, s[32:35], s73 offen nt lds
    s_addk_i32 m0, 0x1000
    s_add_u32 s73, s73, 294912
    buffer_load_dwordx4 v6, s[32:35], s73 offen nt lds
    s_addk_i32 m0, 0x1000
    s_add_u32 s73, s73, 294912
    buffer_load_dwordx4 v6, s[32:35], s73 offen nt lds
    s_addk_i32 m0, 0x1000
    s_add_u32 s73, s73, 294912
    s_mov_b32 s73, s59
    buffer_load_dwordx4 v3, s[24:27], s73 offen  lds
    s_addk_i32 m0, 0x1000
    s_addk_i32 s73, 128
    buffer_load_dwordx4 v3, s[24:27], s73 offen  lds
    s_addk_i32 m0, 0x1000
    s_addk_i32 s73, 128
    buffer_load_dwordx4 v3, s[24:27], s73 offen  lds
    s_addk_i32 m0, 0x1000
    s_addk_i32 s73, 128
    buffer_load_dwordx4 v3, s[24:27], s73 offen  lds
    s_addk_i32 m0, 0x1000
    s_addk_i32 s73, 128
    buffer_load_dwordx4 v3, s[24:27], s73 offen  lds
    s_addk_i32 m0, 0x1000
    s_addk_i32 s73, 128
    buffer_load_dwordx4 v3, s[24:27], s73 offen  lds
    s_addk_i32 m0, 0x1000
    s_addk_i32 s73, 128
    buffer_load_dwordx4 v3, s[24:27], s73 offen  lds
    s_addk_i32 m0, 0x1000
    s_addk_i32 s73, 128
    buffer_load_dwordx4 v3, s[24:27], s73 offen  lds
    s_addk_i32 m0, 0x1000
    s_addk_i32 s73, 128
    buffer_load_dwordx4 v3, s[24:27], s73 offen  lds
    s_addk_i32 m0, 0x1000
    s_addk_i32 s73, 128
    buffer_load_dwordx4 v[56:59], v2, s[20:23], s52 offen sc1
    buffer_load_dword v88, v207, s[20:23], 0 offen sc1
    buffer_load_dword v89, v207, s[20:23], 0 offen offset:512 sc1
    v_mov_b32 v36, 0
    v_mov_b32 v37, 0
    v_mov_b32 v38, 0
    v_mov_b32 v39, 0
    v_mov_b32 v40, 0
    v_mov_b32 v41, 0
    v_mov_b32 v42, 0
    v_mov_b32 v43, 0
    v_mov_b32 v60, s54
    v_mov_b32 v61, s54
    v_mov_b32 v62, s54
    v_mov_b32 v63, s54
    s_sub_u32 s48, s3, s51
    s_add_u32 s48, s48, 2
    s_lshl_b32 s64, s4, 7
    s_add_u32 s64, s64, 618496
    v_mov_b32 v66, 1
    v_mov_b32_e64 v67, 0
    s_mov_b32 s66, 0xaaaaaaaa
    s_mov_b32 s67, 0xaaaaaaaa
    v_mov_b32 v64, 0x3ae38e39
    v_mov_b32 v65, 0xc0135761
    s_waitcnt vmcnt(12)
    s_barrier
    ds_read_b64_tr_b16 a[0:1], v4 offset:0
    ds_read_b64_tr_b16 a[2:3], v4 offset:512
    ds_read_b64_tr_b16 a[4:5], v4 offset:4096
    ds_read_b64_tr_b16 a[6:7], v4 offset:4608
    ds_read_b64_tr_b16 a[8:9], v4 offset:8192
    ds_read_b64_tr_b16 a[10:11], v4 offset:8704
    ds_read_b64_tr_b16 a[12:13], v4 offset:12288
    ds_read_b64_tr_b16 a[14:15], v4 offset:12800
    ds_read_b64_tr_b16 a[16:17], v4 offset:16384
    ds_read_b64_tr_b16 a[18:19], v4 offset:16896
    ds_read_b64_tr_b16 a[20:21], v4 offset:20480
    ds_read_b64_tr_b16 a[22:23], v4 offset:20992
    ds_read_b64_tr_b16 a[24:25], v4 offset:24576
    ds_read_b64_tr_b16 a[26:27], v4 offset:25088
    ds_read_b64_tr_b16 a[28:29], v4 offset:28672
    ds_read_b64_tr_b16 a[30:31], v4 offset:29184
    ds_read_b64_tr_b16 a[32:33], v4 offset:32768
    ds_read_b64_tr_b16 a[34:35], v4 offset:33280
    ds_read_b64_tr_b16 a[36:37], v5 offset:0
    ds_read_b64_tr_b16 a[38:39], v5 offset:512
    ds_read_b64_tr_b16 a[40:41], v5 offset:4096
    ds_read_b64_tr_b16 a[42:43], v5 offset:4608
    ds_read_b64_tr_b16 a[44:45], v5 offset:8192
    ds_read_b64_tr_b16 a[46:47], v5 offset:8704
    ds_read_b64_tr_b16 a[48:49], v5 offset:12288
    ds_read_b64_tr_b16 a[50:51], v5 offset:12800
    ds_read_b64_tr_b16 a[52:53], v5 offset:16384
    ds_read_b64_tr_b16 a[54:55], v5 offset:16896
    ds_read_b64_tr_b16 a[56:57], v5 offset:20480
    ds_read_b64_tr_b16 a[58:59], v5 offset:20992
    ds_read_b64_tr_b16 a[60:61], v5 offset:24576
    ds_read_b64_tr_b16 a[62:63], v5 offset:25088
    ds_read_b64_tr_b16 a[64:65], v5 offset:28672
    ds_read_b64_tr_b16 a[66:67], v5 offset:29184
    ds_read_b64_tr_b16 a[68:69], v5 offset:32768
    ds_read_b64_tr_b16 a[70:71], v5 offset:33280
    s_mov_b64 s[44:45], 0
    s_mov_b64 s[46:47], 0
    s_mov_b32 s60, 0
    s_waitcnt vmcnt(0)
    s_branch L_fs1
L_fs:
    buffer_load_dword v88, v207, s[20:23], 0 offen sc1
    buffer_load_dword v89, v207, s[20:23], 0 offen offset:512 sc1
    s_add_u32 s60, s60, 1
    s_cmp_gt_u32 s60, 2097152
    s_cbranch_scc1 L_fall
    s_waitcnt vmcnt(0)
L_fs1:
    v_cmp_eq_u32 s[40:41], s54, v88
    v_cmp_eq_u32 s[42:43], s54, v89
    s_andn2_b64 exec, s[40:41], s[44:45]
    s_cbranch_execz L_fs_88
    s_cmp_eq_u32 s3, 0
    s_cbranch_scc0 L_fb_90
    buffer_load_dwordx4 v[36:39], v2, s[20:23], s65 offen offset:0 sc1
L_fb_90:
    buffer_load_dwordx4 v[20:23], v2, s[20:23], s63 offen offset:0 sc1
    buffer_load_dwordx4 v[28:31], v2, s[20:23], s63 offen offset:2048 sc1
L_fs_88:
    s_andn2_b64 exec, s[42:43], s[46:47]
    s_cbranch_execz L_fs_89
    s_cmp_eq_u32 s3, 0
    s_cbranch_scc0 L_fb_91
    buffer_load_dwordx4 v[40:43], v2, s[20:23], s65 offen offset:1024 sc1
L_fb_91:
    buffer_load_dwordx4 v[24:27], v2, s[20:23], s63 offen offset:1024 sc1
    buffer_load_dwordx4 v[32:35], v2, s[20:23], s63 offen offset:3072 sc1
L_fs_89:
    s_mov_b64 exec, -1
    s_mov_b64 s[44:45], s[40:41]
    s_mov_b64 s[46:47], s[42:43]
    s_and_b64 s[40:41], s[40:41], s[42:43]
    s_cmp_eq_u64 s[40:41], -1
    s_cbranch_scc0 L_fs
L_fs9:
L_fdn:
    s_cmp_eq_u32 s48, 3
    s_cbranch_scc0 L_fna
    s_mov_b64 exec, 1
    buffer_atomic_add v66, v67, s[20:23], s64 offen sc0 sc1
    s_mov_b64 exec, -1
    s_waitcnt vmcnt(1)
    s_branch L_fchk
L_fall:
    s_mov_b64 exec, -1
    s_cmp_eq_u32 s3, 0
    s_cbranch_scc0 L_fb_92
    buffer_load_dwordx4 v[36:39], v2, s[20:23], s65 offen offset:0 sc1
    buffer_load_dwordx4 v[40:43], v2, s[20:23], s65 offen offset:1024 sc1
L_fb_92:
    buffer_load_dwordx4 v[20:23], v2, s[20:23], s63 offen offset:0 sc1
    buffer_load_dwordx4 v[28:31], v2, s[20:23], s63 offen offset:2048 sc1
    buffer_load_dwordx4 v[24:27], v2, s[20:23], s63 offen offset:1024 sc1
    buffer_load_dwordx4 v[32:35], v2, s[20:23], s63 offen offset:3072 sc1
    s_branch L_fdn
L_fa:
    s_mov_b64 exec, vcc
    s_cmp_eq_u32 s3, 0
    s_cbranch_scc0 L_fb_93
    buffer_load_dwordx4 v[36:39], v2, s[20:23], s65 offen offset:0 sc1
    buffer_load_dwordx4 v[40:43], v2, s[20:23], s65 offen offset:1024 sc1
L_fb_93:
    buffer_load_dwordx4 v[20:23], v2, s[20:23], s63 offen offset:0 sc1
    buffer_load_dwordx4 v[28:31], v2, s[20:23], s63 offen offset:2048 sc1
    buffer_load_dwordx4 v[24:27], v2, s[20:23], s63 offen offset:1024 sc1
    buffer_load_dwordx4 v[32:35], v2, s[20:23], s63 offen offset:3072 sc1
    s_mov_b64 exec, -1
L_fna:
    s_waitcnt vmcnt(0)
L_fchk:
    v_mfma_f32_16x16x32_bf16 v[72:75], v[184:187], v[36:39], v[176:179]
    v_max3_u32 v99, v36, v37, v38
    v_max_u32 v99, v39, v99
    v_mfma_f32_16x16x32_bf16 v[68:71], v[184:187], v[20:23], v[172:175]
    v_max3_u32 v99, v20, v21, v99
    v_max3_u32 v99, v22, v23, v99
    v_mfma_f32_16x16x32_bf16 v[72:75], v[184:187], v[40:43], v[72:75]
    v_max3_u32 v99, v40, v41, v99
    v_max3_u32 v99, v42, v43, v99
    v_mfma_f32_16x16x32_bf16 v[68:71], v[184:187], v[24:27], v[68:71]
    v_max3_u32 v99, v24, v25, v99
    v_max3_u32 v99, v26, v27, v99
    v_mfma_f32_16x16x32_bf16 v[68:71], v[188:191], v[28:31], v[68:71]
    v_max3_u32 v99, v28, v29, v99
    v_max3_u32 v99, v30, v31, v99
    v_mfma_f32_16x16x32_bf16 v[68:71], v[188:191], v[32:35], v[68:71]
    v_max3_u32 v99, v32, v33, v99
    v_max3_u32 v99, v34, v35, v99
    v_cvt_pk_bf16_f32 v82, v72, v73
    v_cvt_pk_bf16_f32 v83, v74, v75
    v_cmp_eq_u32 vcc, -1, v99
    s_cbranch_vccnz L_again_95
L_ok_94:
    s_nop 1
    v_cvt_pk_bf16_f32 v80, v68, v69
    v_cvt_pk_bf16_f32 v81, v70, v71
    s_cmp_eq_u32 s3, 0
    ds_write_b64 v192, v[80:81]
    s_cbranch_scc0 L_fw8
    ds_write_b64 v192, v[82:83] offset:2176
L_fw8:
    v_add_f32 v86, v68, v69
    v_mul_f32 v87, v68, v68
    v_fmac_f32 v87, v69, v69
    v_add_f32 v86, v86, v70
    v_fmac_f32 v87, v70, v70
    v_add_f32 v86, v86, v71
    v_fmac_f32 v87, v71, v71
    v_add_f32 v86, v86, v72
    v_fmac_f32 v87, v72, v72
    s_waitcnt lgkmcnt(0)
    s_barrier
    ds_read_b128 v[20:23], v194 offset:0
    ds_read_b128 v[24:27], v194 offset:272
    ds_read_b128 v[28:31], v194 offset:544
    ds_read_b128 v[32:35], v194 offset:816
    v_add_f32 v86, v86, v73
    v_fmac_f32 v87, v73, v73
    v_add_f32 v86, v86, v74
    v_fmac_f32 v87, v74, v74
    v_add_f32 v86, v86, v75
    v_fmac_f32_e64 v87, v75, v75
    s_nop 0
    v_add_f32_dpp v86, v86, v86 quad_perm:[1,0,3,2] row_mask:0xf bank_mask:0xf
    v_add_f32_dpp v87, v87, v87 quad_perm:[1,0,3,2] row_mask:0xf bank_mask:0xf
    s_nop 0
    v_add_f32_dpp v86, v86, v86 row_ror:8 row_mask:0xf bank_mask:0xf
    v_add_f32_dpp v87, v87, v87 row_ror:8 row_mask:0xf bank_mask:0xf
    ds_write_b64 v193, v[86:87]
    s_waitcnt lgkmcnt(4)
    v_mfma_f32_16x16x32_bf16 v[8:11], v[20:23], a[0:3], 0
    ds_read_b128 v[36:39], v194 offset:1088
    v_mfma_f32_16x16x32_bf16 v[12:15], v[20:23], a[36:39], 0
    s_waitcnt lgkmcnt(4)
    v_mfma_f32_16x16x32_bf16 v[8:11], v[24:27], a[4:7], v[8:11]
    ds_read_b128 v[40:43], v194 offset:1360
    v_mfma_f32_16x16x32_bf16 v[12:15], v[24:27], a[40:43], v[12:15]
    s_waitcnt lgkmcnt(4)
    v_mfma_f32_16x16x32_bf16 v[8:11], v[28:31], a[8:11], v[8:11]
    ds_read_b128 v[44:47], v194 offset:1632
    v_mfma_f32_16x16x32_bf16 v[12:15], v[28:31], a[44:47], v[12:15]
    s_waitcnt lgkmcnt(3)
    s_barrier
    ds_read_b64 v[86:87], v195
    v_mfma_f32_16x16x32_bf16 v[8:11], v[32:35], a[12:15], v[8:11]
    ds_read_b128 v[48:51], v194 offset:1904
    v_mfma_f32_16x16x32_bf16 v[12:15], v[32:35], a[48:51], v[12:15]
    s_waitcnt lgkmcnt(4)
    v_mfma_f32_16x16x32_bf16 v[8:11], v[36:39], a[16:19], v[8:11]
    ds_read_b128 v[52:55], v194 offset:2176
    v_mfma_f32_16x16x32_bf16 v[12:15], v[36:39], a[52:55], v[12:15]
    s_waitcnt lgkmcnt(4)
    v_mfma_f32_16x16x32_bf16 v[8:11], v[40:43], a[20:23], v[8:11]
    v_mfma_f32_16x16x32_bf16 v[12:15], v[40:43], a[56:59], v[12:15]
    s_waitcnt lgkmcnt(2)
    v_add_f32_dpp v86, v86, v86 quad_perm:[1,0,3,2] row_mask:0xf bank_mask:0xf
    v_add_f32_dpp v87, v87, v87 quad_perm:[1,0,3,2] row_mask:0xf bank_mask:0xf
    v_mfma_f32_16x16x32_bf16 v[8:11], v[44:47], a[24:27], v[8:11]
    v_mfma_f32_16x16x32_bf16 v[12:15], v[44:47], a[60:63], v[12:15]
    v_add_f32_dpp v86, v86, v86 quad_perm:[2,3,0,1] row_mask:0xf bank_mask:0xf
    v_add_f32_dpp v87, v87, v87 quad_perm:[2,3,0,1] row_mask:0xf bank_mask:0xf
    s_waitcnt lgkmcnt(1)
    v_mfma_f32_16x16x32_bf16 v[8:11], v[48:51], a[28:31], v[8:11]
    v_mfma_f32_16x16x32_bf16 v[12:15], v[48:51], a[64:67], v[12:15]
    v_add_f32_dpp v86, v86, v86 row_half_mirror row_mask:0xf bank_mask:0xf
    v_add_f32_dpp v87, v87, v87 row_half_mirror row_mask:0xf bank_mask:0xf
    s_waitcnt lgkmcnt(0)
    v_mfma_f32_16x16x32_bf16 v[8:11], v[52:55], a[32:35], v[8:11]
    v_mfma_f32_16x16x32_bf16 v[12:15], v[52:55], a[68:71], v[12:15]
    v_add_f32_dpp v86, v86, v86 row_mirror row_mask:0xf bank_mask:0xf
    v_add_f32_dpp v87, v87, v87 row_mirror row_mask:0xf bank_mask:0xf
    s_cmp_eq_u32 s53, 1
    s_cbranch_scc1 L_frx
    v_cndmask_b32 v18, v86, v87, s[66:67]
    v_xor_b32_e64 v19, s0, v18
    s_nop 1
    v_cvt_pk_bf16_f32 v16, v8, v12
    v_cvt_pk_bf16_f32 v17, v9, v13
    v_bitop3_b32 v19, v16, v17, v19 bitop3:0x96
    s_cmp_eq_u32 s49, 1
    s_cbranch_scc0 L_far_96
    buffer_store_dwordx4 v[16:19], v2, s[20:23], s52 offen
    s_branch L_st_97
L_far_96:
    buffer_store_dwordx4 v[16:19], v2, s[20:23], s52 offen sc1
L_st_97:
    ds_read_b64 v[80:81], v180
    ds_read_b64 v[82:83], v181
    ds_read_b64 v[84:85], v182
    ds_read_b64_tr_b16 v[100:101], v248 offset:0
    ds_read_b64_tr_b16 v[102:103], v248 offset:512
    ds_read_b64_tr_b16 v[104:105], v249 offset:0
    ds_read_b64_tr_b16 v[106:107], v249 offset:512
    ds_read_b64_tr_b16 v[108:109], v250 offset:0
    ds_read_b64_tr_b16 v[110:111], v250 offset:512
    ds_read_b64_tr_b16 v[112:113], v251 offset:0
    ds_read_b64_tr_b16 v[114:115], v251 offset:512
    ds_read_b64_tr_b16 v[116:117], v248 offset:4096
    ds_read_b64_tr_b16 v[118:119], v248 offset:4608
    ds_read_b64_tr_b16 v[120:121], v249 offset:4096
    ds_read_b64_tr_b16 v[122:123], v249 offset:4608
    ds_read_b64_tr_b16 v[124:125], v250 offset:4096
    ds_read_b64_tr_b16 v[126:127], v250 offset:4608
    ds_read_b64_tr_b16 v[128:129], v251 offset:4096
    ds_read_b64_tr_b16 v[130:131], v251 offset:4608
    ds_read_b64_tr_b16 v[132:133], v248 offset:8192
    ds_read_b64_tr_b16 v[134:135], v248 offset:8704
    s_waitcnt lgkmcnt(15)
    v_lshlrev_b32 v68, 16, v80
    v_and_b32 v69, s78, v80
    v_lshlrev_b32 v70, 16, v81
    v_and_b32 v71, s78, v81
    v_lshlrev_b32 v72, 16, v82
    v_and_b32 v73, s78, v82
    v_lshlrev_b32 v74, 16, v83
    v_and_b32 v75, s78, v83
    v_lshlrev_b32 v76, 16, v84
    v_and_b32 v77, s78, v84
    v_lshlrev_b32 v78, 16, v85
    v_and_b32 v79, s78, v85
    s_lshl_b32 s82, s2, 2
    s_add_u32 s82, s82, s3
    s_cmp_eq_u32 s82, 3
    s_cbranch_scc0 L_fact
    s_mov_b32 s82, 65536
    s_mov_b64 exec, 0xff
    buffer_store_dwordx4 v[60:63], v2, s[20:23], s82 offen sc1
    s_mov_b64 exec, -1
    s_branch L_fact
L_frx:
    buffer_load_dwordx4 v[56:59], v2, s[20:23], s52 offen sc1
    ds_read_b64 v[80:81], v180
    ds_read_b64 v[82:83], v181
    ds_read_b64 v[84:85], v182
    ds_read_b64_tr_b16 v[100:101], v248 offset:0
    ds_read_b64_tr_b16 v[102:103], v248 offset:512
    ds_read_b64_tr_b16 v[104:105], v249 offset:0
    ds_read_b64_tr_b16 v[106:107], v249 offset:512
    ds_read_b64_tr_b16 v[108:109], v250 offset:0
    ds_read_b64_tr_b16 v[110:111], v250 offset:512
    ds_read_b64_tr_b16 v[112:113], v251 offset:0
    ds_read_b64_tr_b16 v[114:115], v251 offset:512
    ds_read_b64_tr_b16 v[116:117], v248 offset:4096
    ds_read_b64_tr_b16 v[118:119], v248 offset:4608
    ds_read_b64_tr_b16 v[120:121], v249 offset:4096
    ds_read_b64_tr_b16 v[122:123], v249 offset:4608
    ds_read_b64_tr_b16 v[124:125], v250 offset:4096
    ds_read_b64_tr_b16 v[126:127], v250 offset:4608
    ds_read_b64_tr_b16 v[128:129], v251 offset:4096
    ds_read_b64_tr_b16 v[130:131], v251 offset:4608
    ds_read_b64_tr_b16 v[132:133], v248 offset:8192
    ds_read_b64_tr_b16 v[134:135], v248 offset:8704
    buffer_load_dwordx4 v[56:59], v2, s[20:23], s52 offen sc1
    s_waitcnt lgkmcnt(15)
    v_lshlrev_b32 v68, 16, v80
    v_and_b32 v69, s78, v80
    v_lshlrev_b32 v70, 16, v81
    v_and_b32 v71, s78, v81
    v_lshlrev_b32 v72, 16, v82
    v_and_b32 v73, s78, v82
    v_lshlrev_b32 v74, 16, v83
    v_and_b32 v75, s78, v83
    v_lshlrev_b32 v76, 16, v84
    v_and_b32 v77, s78, v84
    v_lshlrev_b32 v78, 16, v85
    v_and_b32 v79, s78, v85
    s_branch L_frx2
L_frx1:
    buffer_load_dwordx4 v[56:59], v2, s[20:23], s52 offen sc1
L_frx2:
    s_waitcnt vmcnt(1)
    v_bitop3_b32 v99, v56, v57, v58 bitop3:0x96
    v_xor_b32 v99, v99, v59
    v_cmp_ne_u32 vcc, s0, v99
    s_cbranch_vccnz L_again_99
L_ok_98:
    v_readfirstlane_b32 s82, v66
    v_add_f32_dpp v86, v58, v86 quad_perm:[0,0,2,2] row_mask:0xf bank_mask:0xf
    v_add_f32_dpp v87, v58, v87 quad_perm:[1,1,3,3] row_mask:0xf bank_mask:0xf
    v_lshlrev_b32 v10, 16, v57
    v_lshlrev_b32_e64 v14, 16, v56
    v_mul_f32 v86, 0x3ae38e39, v86
    v_fmaak_f32 v87, v87, v64, 0x3727c5ac
    v_add_f32 v9, v9, v10
    v_fma_f32 v87, -v86, v86, v87
    v_add_f32 v8, v8, v14
    v_max_f32 v87, 0x3727c5ac, v87
    v_and_b32 v11, s78, v57
    v_rsq_f32 v87, v87
    v_and_b32 v15, s78, v56
    v_fma_f32 v8, -v86, v9, v8
    v_add_f32 v13, v13, v11
    v_mul_f32 v8, v8, v87
    v_add_f32 v12, v12, v15
    v_mul_f32 v9, v8, v8
    v_fma_f32 v12, -v86, v13, v12
    v_fmamk_f32 v9, v9, 0xbdd2d3e8, v65
    v_mul_f32 v12, v12, v87
    v_mul_f32 v9, v9, v8
    v_exp_f32 v9, v9
    v_mul_f32 v8, v8, v12
    v_add_f32 v9, 1.0, v9
    v_rcp_f32 v9, v9
    s_nop 0
    v_mul_f32_e64 v8, v8, v9
    v_cvt_pk_bf16_f32 v8, v8, v8
    ds_write_b16 v196, v8
    s_cmp_eq_u32 s82, 16
    s_cbranch_scc0 L_fnc
    buffer_store_dwordx4 v[60:63], v205, s[20:23], s61 offen sc1
L_fnc:
    s_waitcnt lgkmcnt(0)
L_fact:
    s_barrier
    ds_read_b128 v[20:23], v197
    ds_read_b128 v[24:27], v198
    ds_read_b128 v[28:31], v199
    s_mov_b32 s82, 0x77777777
    s_mov_b32 s83, 0x77777777
    s_mov_b32 s75, 0xbfffbfff
    v_mov_b32 v88, s0
    s_waitcnt lgkmcnt(2)
    v_mfma_f32_16x16x32_bf16 v[72:75], v[112:115], v[20:23], v[72:75]
    v_mfma_f32_16x16x32_bf16 v[68:71], v[100:103], v[20:23], v[68:71]
    v_mfma_f32_16x16x32_bf16 v[76:79], v[124:127], v[20:23], v[76:79]
    s_waitcnt lgkmcnt(1)
    v_mfma_f32_16x16x32_bf16 v[72:75], v[116:119], v[24:27], v[72:75]
    v_mfma_f32_16x16x32_bf16 v[68:71], v[104:107], v[24:27], v[68:71]
    v_mfma_f32_16x16x32_bf16 v[76:79], v[128:131], v[24:27], v[76:79]
    s_waitcnt lgkmcnt(0)
    v_mfma_f32_16x16x32_bf16 v[72:75], v[120:123], v[28:31], v[72:75]
    v_mfma_f32_16x16x32_bf16 v[68:71], v[108:111], v[28:31], v[68:71]
    v_mfma_f32_16x16x32_bf16 v[76:79], v[132:135], v[28:31], v[76:79]
    s_mov_b64 exec, s[82:83]
    s_nop 4
    v_cvt_pk_bf16_f32 v82, v72, v73
    v_cvt_pk_bf16_f32 v86, v74, v75
    v_cvt_pk_bf16_f32 v80, v68, v69
    v_cvt_pk_bf16_f32 v81, v70, v71
    v_bitop3_b32 v83, v80, v81, v82 bitop3:0x96
    v_bitop3_b32 v83, v83, v88, s75 bitop3:0x28
    buffer_store_dwordx4 v[80:83], v203, s[20:23], s62 offen sc1
    v_cvt_pk_bf16_f32 v84, v76, v77
    v_cvt_pk_bf16_f32 v85, v78, v79
    v_bitop3_b32 v87, v84, v85, v86 bitop3:0x96
    v_bitop3_b32 v87, v87, v88, s75 bitop3:0x28
    buffer_store_dwordx4 v[84:87], v203, s[20:23], s71 offen sc1
    s_endpgm
L_again_95:
    s_add_u32 s81, s81, 1
    s_cmp_lt_u32 s81, 2097152
    s_cbranch_scc1 L_fa
    s_branch L_ok_94
L_again_99:
    s_add_u32 s81, s81, 1
    s_cmp_lt_u32 s81, 2097152
    s_cbranch_scc1 L_frx1
    s_branch L_ok_98
L_end:
    s_endpgm
.section .rodata,"a"
.p2align 6
.amdhsa_kernel sequential_preLN__sliding_block_cached__geglu_ffn__decode_kernel
  .amdhsa_next_free_vgpr 512
  .amdhsa_next_free_sgpr 102
  .amdhsa_accum_offset 256
  .amdhsa_group_segment_fixed_size 0
  .amdhsa_kernarg_size 96
  .amdhsa_user_sgpr_count 2
  .amdhsa_user_sgpr_kernarg_segment_ptr 1
  .amdhsa_system_sgpr_workgroup_id_x 1
.end_amdhsa_kernel
```
